```python
import torch

def _softmax(x, axis=-1):
    return torch.softmax(x, dim=axis)
def _gelu(x):
    return torch.nn.functional.gelu(x, approximate="tanh")
def _silu(x):
    return torch.nn.functional.silu(x)
def _sigmoid(x):
    return torch.sigmoid(x)
def _layernorm(x, axis=-1, eps=1e-5):
    m = x.mean(dim=axis, keepdim=True)
    v = x.var(dim=axis, keepdim=True, unbiased=False)
    return (x - m) / torch.sqrt(v + eps)
def _scatter_add(tgt, idx, src, axis=0):
    return tgt.clone().index_add_(axis, idx, src)
def _segment_sum(src, seg, n):
    out = torch.zeros((n,) + src.shape[1:], dtype=src.dtype)
    return out.index_add_(0, seg, src)
def _pad(x, pw):
    flat = tuple(v for pair in reversed(pw) for v in pair)
    return torch.nn.functional.pad(x, flat)

kernel_name = 'sequential_preLN__mha_block_cached__swiglu_ffn__decode'

def setup_inputs():

    _w = (lambda a: (lambda t: t.to(torch.bfloat16) if t.is_floating_point() else t)(torch.as_tensor(a)))
    def _A_setup():
        B, Sq, D = 8, 1, 640
        H, Sk, Dh = 32, 4096, 128
        return {
            "x": _w((lambda *s: torch.randn(*s, dtype=torch.bfloat16) * 0.05)(B, Sq, D)),
            "k_cache": _w((lambda *s: torch.randn(*s, dtype=torch.bfloat16) * 3.2)(B, H, Sk, Dh)),
            "v_cache": _w((lambda *s: torch.randn(*s, dtype=torch.bfloat16) * 0.4)(B, H, Sk, Dh)),
            "wq": _w((lambda *s: torch.randn(*s, dtype=torch.bfloat16) * 3.2)(D, H * Dh) * (D ** -0.5)),
            "wo": _w((lambda *s: torch.randn(*s, dtype=torch.bfloat16) * 0.4)(H * Dh, D) * ((H * Dh) ** -0.5)),
        }
    _A_in = _A_setup()

    def _B_setup():
        B, S, D, F = 8, 1, 640, 1728
        return {
            "x": _w((lambda *s: torch.randn(*s, dtype=torch.bfloat16) * 0.05)(B, S, D)),
            "w_gate": _w((lambda *s: torch.randn(*s, dtype=torch.bfloat16) * 0.05)(D, F)),
            "w_up": _w((lambda *s: torch.randn(*s, dtype=torch.bfloat16) * 0.05)(D, F)),
            "w_down": _w((lambda *s: torch.randn(*s, dtype=torch.bfloat16) * 0.05)(F, D)),
        }
    _B_in = _B_setup()

    return {
        "A_x": _A_in["x"],
        "A_k_cache": _A_in["k_cache"],
        "A_v_cache": _A_in["v_cache"],
        "A_wq": _A_in["wq"],
        "A_wo": _A_in["wo"],
        "B_x": _B_in["x"],
        "B_w_gate": _B_in["w_gate"],
        "B_w_up": _B_in["w_up"],
        "B_w_down": _B_in["w_down"],
    }

def reference(A_x, A_k_cache, A_v_cache, A_wq, A_wo, B_x, B_w_gate, B_w_up, B_w_down):
    def _A_ref(x, k_cache, v_cache, wq, wo):
        B, Sq, D = x.shape
        H, Dh = 32, 128
        q = (lambda x, *d: x.permute(*d))((x @ wq).reshape(B, Sq, H, Dh), 0, 2, 1, 3)
        scores = torch.einsum("bhqd,bhkd->bhqk", q, k_cache) * (Dh ** -0.5)
        p = _softmax(scores, axis=-1)
        o = torch.einsum("bhqk,bhkd->bhqd", p, v_cache)
        return (lambda x, *d: x.permute(*d))(o, 0, 2, 1, 3).reshape(B, Sq, H * Dh) @ wo

    def _B_ref(x, w_gate, w_up, w_down):
        g = _silu(x @ w_gate)
        u = x @ w_up
        return (g * u) @ w_down

    x = A_x
    h = x + _A_ref(_layernorm(x, axis=-1), A_k_cache, A_v_cache, A_wq, A_wo)
    h2 = h + _B_ref(_layernorm(h, axis=-1), B_w_gate, B_w_up, B_w_down)
    return h2
```

```asm
; @launch grid=(256,1,1) block=(512,1,1) lds=103680
.amdgcn_target "amdgcn-amd-amdhsa--gfx950"
.text
.globl sequential_preLN__mha_block_cached__swiglu_ffn__decode_kernel
.p2align 8
.type sequential_preLN__mha_block_cached__swiglu_ffn__decode_kernel,@function
sequential_preLN__mha_block_cached__swiglu_ffn__decode_kernel:
    s_cmp_ge_u32 s2, 256
    s_cbranch_scc1 L_end
    s_load_dwordx16 s[16:31], s[0:1], 0
    s_load_dwordx8 s[32:39], s[0:1], 64
    v_lshrrev_b32 v2, 6, v0
    v_and_b32 v1, 63, v0
    v_readfirstlane_b32 s3, v2
    s_lshr_b32 s4, s2, 5
    s_and_b32 s5, s2, 31
    s_cmp_ge_u32 s3, 4
    s_cbranch_scc1 L_helper
    v_bfe_u32 v2, v1, 2, 2
    v_lshlrev_b32 v2, 8, v2
    v_lshrrev_b32 v3, 4, v1
    v_lshl_add_u32 v2, v3, 6, v2
    v_and_b32 v3, 3, v1
    v_lshl_add_u32 v2, v3, 4, v2
    s_lshl_b32 s6, s2, 20
    s_lshl_b32 s44, s3, 12
    s_mov_b32 s42, 0x100000
    s_mov_b32 s43, 0x20000
    s_waitcnt lgkmcnt(0)
    s_add_u32 s40, s18, s6
    s_addc_u32 s41, s19, 0
    buffer_load_dwordx4 v[64:67], v2, s[40:43], s44 offen offset:0 nt
    buffer_load_dwordx4 v[68:71], v2, s[40:43], s44 offen offset:1024 nt
    buffer_load_dwordx4 v[72:75], v2, s[40:43], s44 offen offset:2048 nt
    buffer_load_dwordx4 v[76:79], v2, s[40:43], s44 offen offset:3072 nt
    s_add_u32 s44, s44, 16384
    s_add_u32 s48, s20, s6
    s_addc_u32 s49, s21, 0
    v_lshlrev_b32 v3, 4, v1
    s_lshl_b32 s7, s5, 3
    s_add_u32 s7, s7, s4
    s_mul_i32 s7, s7, 20480
    s_mul_i32 s8, s3, 5120
    s_add_u32 s7, s7, s8
    s_add_u32 s10, s24, s7
    s_addc_u32 s11, s25, 0
    global_load_dwordx4 v[56:59], v3, s[10:11]
    global_load_dwordx4 v[56:59], v3, s[10:11] offset:1024
    global_load_dwordx4 v[56:59], v3, s[10:11] offset:2048
    global_load_dwordx4 v[56:59], v3, s[10:11] offset:3072
    v_add_u32 v8, 4096, v3
    global_load_dwordx4 v[56:59], v8, s[10:11]
    s_and_b32 s12, s2, 7
    s_lshr_b32 s13, s2, 3
    s_min_u32 s14, s12, 3
    s_lshl_b32 s14, s14, 2
    s_mul_i32 s67, s12, 12
    s_add_u32 s67, s67, s14
    s_add_u32 s67, s67, s13
    s_cmp_lt_u32 s12, 3
    s_cselect_b32 s14, 16, 12
    s_mov_b32 s66, 0
    s_sub_u32 s13, s13, s14
    s_cbranch_scc1 L_role0
    s_sub_u32 s14, s12, 3
    s_max_i32 s14, s14, 0
    s_min_i32 s14, s14, 2
    s_add_u32 s14, s14, s12
    s_lshl_b32 s14, s14, 2
    s_add_u32 s67, s14, s13
    s_sub_u32 s14, s12, 3
    s_cmp_lt_u32 s14, 2
    s_cselect_b32 s14, 8, 4
    s_mov_b32 s66, 1
    s_sub_u32 s13, s13, s14
    s_cbranch_scc1 L_role0
    s_mov_b32 s67, s13
    s_mov_b32 s66, 2
    s_cmp_lt_u32 s13, 10
    s_cbranch_scc1 L_role0
    s_mov_b32 s66, 3
    s_mov_b32 s67, 0
L_role0:
    v_and_b32 v8, 15, v1
    v_lshlrev_b32 v8, 3, v8
    s_min_u32 s8, s67, 9
    s_lshl_b32 s8, s8, 7
    s_mul_i32 s7, s12, 1280
    s_add_u32 s7, s7, s8
    v_add_u32 v44, s7, v8
    global_load_dwordx2 v[42:43], v44, s[16:17]
    v_and_b32 v8, 15, v1
    v_and_b32 v9, 1, v1
    v_lshlrev_b32 v9, 4, v9
    v_mov_b32 v10, 0xffff
    v_lshlrev_b32 v10, v9, v10
    v_lshrrev_b32 v11, 1, v8
    v_cmp_eq_u32 vcc, 0, v11
    s_nop 1
    v_cndmask_b32 v4, 0, v10, vcc
    v_cmp_eq_u32 vcc, 1, v11
    s_nop 1
    v_cndmask_b32 v5, 0, v10, vcc
    v_cmp_eq_u32 vcc, 2, v11
    s_nop 1
    v_cndmask_b32 v6, 0, v10, vcc
    v_cmp_eq_u32 vcc, 3, v11
    s_nop 1
    v_cndmask_b32 v7, 0, v10, vcc
    s_mov_b32 s50, 0xaaaaaaaa
    s_mov_b32 s51, 0xaaaaaaaa
    s_mov_b32 s52, 0xcccccccc
    s_mov_b32 s53, 0xcccccccc
    s_mov_b32 s54, 0x3db504f3
    s_mov_b32 s55, 0x3fb8aa3b
    v_mov_b32 v34, 0xff7fffff
    v_mov_b32 v36, 0
    s_mul_i32 s7, s3, 4096
    s_add_u32 s7, s7, 9344
    v_and_b32 v35, 60, v1
    v_add_u32 v35, s7, v35
    v_lshrrev_b32 v8, 4, v1
    v_lshlrev_b32 v8, 2, v8
    v_and_b32 v9, 3, v1
    v_add_u32 v8, v8, v9
    v_lshlrev_b32 v45, 5, v8
    s_lshl_b32 s7, s3, 4
    v_mov_b32 v61, s7
    ds_write_b32 v61, v36 offset:9224
    ds_write_b32 v36, v36 offset:9280
    v_and_b32 v8, 15, v1
    v_lshlrev_b32 v8, 5, v8
    v_lshrrev_b32 v9, 4, v1
    v_lshl_add_u32 v8, v9, 4, v8
    s_lshl_b32 s7, s3, 9
    v_add_u32 v60, s7, v8
    s_waitcnt lgkmcnt(0)
    s_waitcnt vmcnt(5)
    buffer_load_dwordx4 v[80:83], v2, s[40:43], s44 offen offset:0 nt
    s_waitcnt vmcnt(5)
    buffer_load_dwordx4 v[84:87], v2, s[40:43], s44 offen offset:1024 nt
    s_waitcnt vmcnt(5)
    buffer_load_dwordx4 v[88:91], v2, s[40:43], s44 offen offset:2048 nt
    s_waitcnt vmcnt(5)
    buffer_load_dwordx4 v[92:95], v2, s[40:43], s44 offen offset:3072 nt
    s_add_u32 s44, s44, 16384
    s_waitcnt vmcnt(5)
    buffer_load_dwordx4 v[96:99], v2, s[40:43], s44 offen offset:0 nt
    s_waitcnt vmcnt(5)
    buffer_load_dwordx4 v[100:103], v2, s[40:43], s44 offen offset:1024 nt
    s_waitcnt vmcnt(5)
    buffer_load_dwordx4 v[104:107], v2, s[40:43], s44 offen offset:2048 nt
    s_waitcnt vmcnt(5)
    buffer_load_dwordx4 v[108:111], v2, s[40:43], s44 offen offset:3072 nt
    s_add_u32 s44, s44, 16384
    s_waitcnt vmcnt(5)
    buffer_load_dwordx4 v[112:115], v2, s[40:43], s44 offen offset:0 nt
    s_waitcnt vmcnt(5)
    buffer_load_dwordx4 v[116:119], v2, s[40:43], s44 offen offset:1024 nt
    s_waitcnt vmcnt(5)
    buffer_load_dwordx4 v[120:123], v2, s[40:43], s44 offen offset:2048 nt
    s_waitcnt vmcnt(5)
    buffer_load_dwordx4 v[124:127], v2, s[40:43], s44 offen offset:3072 nt
    s_add_u32 s44, s44, 16384
    s_waitcnt vmcnt(5)
    buffer_load_dwordx4 v[128:131], v2, s[40:43], s44 offen offset:0 nt
    s_waitcnt vmcnt(5)
    buffer_load_dwordx4 v[132:135], v2, s[40:43], s44 offen offset:1024 nt
    s_waitcnt vmcnt(5)
    buffer_load_dwordx4 v[136:139], v2, s[40:43], s44 offen offset:2048 nt
    s_waitcnt vmcnt(5)
    buffer_load_dwordx4 v[140:143], v2, s[40:43], s44 offen offset:3072 nt
    s_add_u32 s44, s44, 16384
    s_waitcnt vmcnt(5)
    buffer_load_dwordx4 v[144:147], v2, s[40:43], s44 offen offset:0 nt
    s_waitcnt vmcnt(5)
    buffer_load_dwordx4 v[148:151], v2, s[40:43], s44 offen offset:1024 nt
    s_waitcnt vmcnt(5)
    buffer_load_dwordx4 v[152:155], v2, s[40:43], s44 offen offset:2048 nt
    s_waitcnt vmcnt(5)
    buffer_load_dwordx4 v[156:159], v2, s[40:43], s44 offen offset:3072 nt
    s_add_u32 s44, s44, 16384
    s_waitcnt vmcnt(5)
    buffer_load_dwordx4 v[160:163], v2, s[40:43], s44 offen offset:0 nt
    s_waitcnt vmcnt(5)
    buffer_load_dwordx4 v[164:167], v2, s[40:43], s44 offen offset:1024 nt
    s_waitcnt vmcnt(5)
    buffer_load_dwordx4 v[168:171], v2, s[40:43], s44 offen offset:2048 nt
    s_waitcnt vmcnt(5)
    buffer_load_dwordx4 v[172:175], v2, s[40:43], s44 offen offset:3072 nt
    s_add_u32 s44, s44, 16384
    s_waitcnt vmcnt(5)
    buffer_load_dwordx4 v[176:179], v2, s[40:43], s44 offen offset:0 nt
    s_waitcnt vmcnt(5)
    buffer_load_dwordx4 v[180:183], v2, s[40:43], s44 offen offset:1024 nt
    s_waitcnt vmcnt(5)
    buffer_load_dwordx4 v[184:187], v2, s[40:43], s44 offen offset:2048 nt
    s_waitcnt vmcnt(5)
    buffer_load_dwordx4 v[188:191], v2, s[40:43], s44 offen offset:3072 nt
    s_add_u32 s44, s44, 16384
    s_waitcnt vmcnt(5)
    buffer_load_dwordx4 v[192:195], v2, s[40:43], s44 offen offset:0 nt
    s_waitcnt vmcnt(5)
    buffer_load_dwordx4 v[196:199], v2, s[40:43], s44 offen offset:1024 nt
    s_waitcnt vmcnt(5)
    buffer_load_dwordx4 v[200:203], v2, s[40:43], s44 offen offset:2048 nt
    s_waitcnt vmcnt(5)
    buffer_load_dwordx4 v[204:207], v2, s[40:43], s44 offen offset:3072 nt
    s_add_u32 s44, s44, 16384
    s_waitcnt vmcnt(5)
    buffer_load_dwordx4 v[208:211], v2, s[40:43], s44 offen offset:0 nt
    s_waitcnt vmcnt(5)
    buffer_load_dwordx4 v[212:215], v2, s[40:43], s44 offen offset:1024 nt
    s_waitcnt vmcnt(5)
    buffer_load_dwordx4 v[216:219], v2, s[40:43], s44 offen offset:2048 nt
    s_waitcnt vmcnt(5)
    buffer_load_dwordx4 v[220:223], v2, s[40:43], s44 offen offset:3072 nt
    s_add_u32 s44, s44, 16384
    s_waitcnt vmcnt(5)
    buffer_load_dwordx4 v[224:227], v2, s[40:43], s44 offen offset:0 nt
    s_waitcnt vmcnt(5)
    buffer_load_dwordx4 v[228:231], v2, s[40:43], s44 offen offset:1024 nt
    s_waitcnt vmcnt(5)
    buffer_load_dwordx4 v[232:235], v2, s[40:43], s44 offen offset:2048 nt
    s_waitcnt vmcnt(5)
    buffer_load_dwordx4 v[236:239], v2, s[40:43], s44 offen offset:3072 nt
    s_add_u32 s44, s44, 16384
    s_waitcnt vmcnt(5)
    buffer_load_dwordx4 v[240:243], v2, s[40:43], s44 offen offset:0 nt
    s_waitcnt vmcnt(5)
    buffer_load_dwordx4 v[244:247], v2, s[40:43], s44 offen offset:1024 nt
    s_waitcnt vmcnt(5)
    buffer_load_dwordx4 v[248:251], v2, s[40:43], s44 offen offset:2048 nt
    s_waitcnt vmcnt(5)
    buffer_load_dwordx4 v[252:255], v2, s[40:43], s44 offen offset:3072 nt
    s_add_u32 s44, s44, 16384
    s_barrier
    ds_read_b128 v[46:49], v45 offset:5120
    ds_read_b128 v[50:53], v45 offset:5136
    ds_read_b128 v[54:57], v45 offset:5632
    ds_read_b128 v[16:19], v45 offset:5648
    ds_read_b128 v[24:27], v45 offset:6144
    ds_read_b128 v[28:31], v45 offset:6160
    ds_read_b128 v[8:11], v45 offset:6656
    ds_read_b128 v[12:15], v45 offset:6672
    s_waitcnt lgkmcnt(0)
    v_add_f32 v46, v46, v54
    v_add_f32 v24, v24, v8
    v_add_f32 v47, v47, v55
    v_add_f32 v25, v25, v9
    v_add_f32 v48, v48, v56
    v_add_f32 v26, v26, v10
    v_add_f32 v49, v49, v57
    v_add_f32 v27, v27, v11
    v_add_f32 v50, v50, v16
    v_add_f32 v28, v28, v12
    v_add_f32 v51, v51, v17
    v_add_f32 v29, v29, v13
    v_add_f32 v52, v52, v18
    v_add_f32 v30, v30, v14
    v_add_f32 v53, v53, v19
    v_add_f32 v31, v31, v15
    v_add_f32 v46, v46, v24
    v_add_f32 v47, v47, v25
    v_add_f32 v48, v48, v26
    v_add_f32 v49, v49, v27
    v_add_f32 v50, v50, v28
    v_add_f32 v51, v51, v29
    v_add_f32 v52, v52, v30
    v_add_f32 v53, v53, v31
    v_cvt_pk_bf16_f32 v54, v46, v47
    v_cvt_pk_bf16_f32 v55, v48, v49
    v_cvt_pk_bf16_f32 v56, v50, v51
    v_cvt_pk_bf16_f32 v57, v52, v53
    s_mov_b32 s56, 0xf000f
    s_mov_b32 s57, 0xf000f
    v_cndmask_b32 v8, 0, v54, s[56:57]
    v_cndmask_b32 v9, 0, v55, s[56:57]
    v_cndmask_b32 v10, 0, v56, s[56:57]
    v_cndmask_b32 v11, 0, v57, s[56:57]
    s_mov_b32 s56, 0xf000f0
    s_mov_b32 s57, 0xf000f0
    v_cndmask_b32 v12, 0, v54, s[56:57]
    v_cndmask_b32 v13, 0, v55, s[56:57]
    v_cndmask_b32 v14, 0, v56, s[56:57]
    v_cndmask_b32 v15, 0, v57, s[56:57]
    s_mov_b32 s56, 0xf000f00
    s_mov_b32 s57, 0xf000f00
    v_cndmask_b32 v16, 0, v54, s[56:57]
    v_cndmask_b32 v17, 0, v55, s[56:57]
    v_cndmask_b32 v18, 0, v56, s[56:57]
    v_cndmask_b32 v19, 0, v57, s[56:57]
    s_mov_b32 s56, 0xf000f000
    s_mov_b32 s57, 0xf000f000
    v_cndmask_b32 v20, 0, v54, s[56:57]
    v_cndmask_b32 v21, 0, v55, s[56:57]
    v_cndmask_b32 v22, 0, v56, s[56:57]
    v_cndmask_b32 v23, 0, v57, s[56:57]
    s_nop 1
    v_mfma_f32_16x16x32_bf16 v[24:27], v[64:67], v[8:11], 0
    v_mfma_f32_16x16x32_bf16 v[24:27], v[68:71], v[12:15], v[24:27]
    v_mfma_f32_16x16x32_bf16 v[24:27], v[72:75], v[16:19], v[24:27]
    s_waitcnt vmcnt(4)
    buffer_load_dwordx4 v[64:67], v2, s[40:43], s44 offen offset:0 nt
    v_mfma_f32_16x16x32_bf16 v[24:27], v[76:79], v[20:23], v[24:27]
    v_mfma_f32_16x16x32_bf16 v[28:31], v[80:83], v[8:11], 0
    v_mfma_f32_16x16x32_bf16 v[28:31], v[84:87], v[12:15], v[28:31]
    s_waitcnt vmcnt(4)
    buffer_load_dwordx4 v[68:71], v2, s[40:43], s44 offen offset:1024 nt
    v_mfma_f32_16x16x32_bf16 v[28:31], v[88:91], v[16:19], v[28:31]
    s_nop 3
    s_nop 1
    v_cndmask_b32 v32, v24, v25, s[50:51]
    v_cndmask_b32 v33, v26, v27, s[50:51]
    v_cndmask_b32 v32, v32, v33, s[52:53]
    s_nop 1
    v_add_f32_dpp v32, v32, v32 quad_perm:[1,0,3,2] row_mask:0xf bank_mask:0xf
    s_nop 1
    v_add_f32_dpp v32, v32, v32 quad_perm:[2,3,0,1] row_mask:0xf bank_mask:0xf
    v_mfma_f32_16x16x32_bf16 v[28:31], v[92:95], v[20:23], v[28:31]
    v_cvt_pk_bf16_f32 v32, v32, v32
    v_lshlrev_b32 v32, 16, v32
    v_mul_f32 v32, s54, v32
    v_cvt_pk_bf16_f32 v32, v32, v32
    v_lshlrev_b32 v32, 16, v32
    v_max_f32 v33, v34, v32
    ds_write_b32 v35, v32 offset:0
    v_sub_f32 v40, v34, v33
    v_sub_f32 v46, v32, v33
    v_mul_f32 v40, s55, v40
    v_mul_f32 v46, s55, v46
    v_exp_f32 v40, v40
    v_exp_f32 v46, v46
    v_mov_b32 v34, v33
    v_fma_f32 v36, v36, v40, v46
    v_mfma_f32_16x16x32_bf16 v[24:27], v[96:99], v[8:11], 0
    s_waitcnt vmcnt(4)
    buffer_load_dwordx4 v[72:75], v2, s[40:43], s44 offen offset:2048 nt
    v_mfma_f32_16x16x32_bf16 v[24:27], v[100:103], v[12:15], v[24:27]
    v_mfma_f32_16x16x32_bf16 v[24:27], v[104:107], v[16:19], v[24:27]
    s_nop 3
    s_nop 1
    v_cndmask_b32 v32, v28, v29, s[50:51]
    v_cndmask_b32 v33, v30, v31, s[50:51]
    v_cndmask_b32 v32, v32, v33, s[52:53]
    s_nop 1
    v_add_f32_dpp v32, v32, v32 quad_perm:[1,0,3,2] row_mask:0xf bank_mask:0xf
    s_nop 1
    v_add_f32_dpp v32, v32, v32 quad_perm:[2,3,0,1] row_mask:0xf bank_mask:0xf
    v_mfma_f32_16x16x32_bf16 v[24:27], v[108:111], v[20:23], v[24:27]
    v_cvt_pk_bf16_f32 v32, v32, v32
    v_lshlrev_b32 v32, 16, v32
    v_mul_f32 v32, s54, v32
    v_cvt_pk_bf16_f32 v32, v32, v32
    v_lshlrev_b32 v32, 16, v32
    v_max_f32 v33, v34, v32
    ds_write_b32 v35, v32 offset:64
    v_sub_f32 v40, v34, v33
    v_sub_f32 v46, v32, v33
    v_mul_f32 v40, s55, v40
    v_mul_f32 v46, s55, v46
    v_exp_f32 v40, v40
    v_exp_f32 v46, v46
    v_mov_b32 v34, v33
    v_fma_f32 v36, v36, v40, v46
    s_waitcnt vmcnt(4)
    buffer_load_dwordx4 v[76:79], v2, s[40:43], s44 offen offset:3072 nt
    s_add_u32 s44, s44, 16384
    v_mfma_f32_16x16x32_bf16 v[28:31], v[112:115], v[8:11], 0
    v_mfma_f32_16x16x32_bf16 v[28:31], v[116:119], v[12:15], v[28:31]
    v_mfma_f32_16x16x32_bf16 v[28:31], v[120:123], v[16:19], v[28:31]
    s_nop 3
    s_nop 1
    v_cndmask_b32 v32, v24, v25, s[50:51]
    v_cndmask_b32 v33, v26, v27, s[50:51]
    v_cndmask_b32 v32, v32, v33, s[52:53]
    s_nop 1
    v_add_f32_dpp v32, v32, v32 quad_perm:[1,0,3,2] row_mask:0xf bank_mask:0xf
    s_nop 1
    v_add_f32_dpp v32, v32, v32 quad_perm:[2,3,0,1] row_mask:0xf bank_mask:0xf
    s_waitcnt vmcnt(4)
    buffer_load_dwordx4 v[80:83], v2, s[40:43], s44 offen offset:0 nt
    v_mfma_f32_16x16x32_bf16 v[28:31], v[124:127], v[20:23], v[28:31]
    v_cvt_pk_bf16_f32 v32, v32, v32
    v_lshlrev_b32 v32, 16, v32
    v_mul_f32 v32, s54, v32
    v_cvt_pk_bf16_f32 v32, v32, v32
    v_lshlrev_b32 v32, 16, v32
    v_max_f32 v33, v34, v32
    ds_write_b32 v35, v32 offset:128
    v_sub_f32 v40, v34, v33
    v_sub_f32 v46, v32, v33
    v_mul_f32 v40, s55, v40
    v_mul_f32 v46, s55, v46
    v_exp_f32 v40, v40
    v_exp_f32 v46, v46
    v_mov_b32 v34, v33
    v_fma_f32 v36, v36, v40, v46
    v_mfma_f32_16x16x32_bf16 v[24:27], v[128:131], v[8:11], 0
    v_mfma_f32_16x16x32_bf16 v[24:27], v[132:135], v[12:15], v[24:27]
    s_waitcnt vmcnt(4)
    buffer_load_dwordx4 v[84:87], v2, s[40:43], s44 offen offset:1024 nt
    v_mfma_f32_16x16x32_bf16 v[24:27], v[136:139], v[16:19], v[24:27]
    s_nop 3
    s_nop 1
    v_cndmask_b32 v32, v28, v29, s[50:51]
    v_cndmask_b32 v33, v30, v31, s[50:51]
    v_cndmask_b32 v32, v32, v33, s[52:53]
    s_nop 1
    v_add_f32_dpp v32, v32, v32 quad_perm:[1,0,3,2] row_mask:0xf bank_mask:0xf
    s_nop 1
    v_add_f32_dpp v32, v32, v32 quad_perm:[2,3,0,1] row_mask:0xf bank_mask:0xf
    v_mfma_f32_16x16x32_bf16 v[24:27], v[140:143], v[20:23], v[24:27]
    v_cvt_pk_bf16_f32 v32, v32, v32
    v_lshlrev_b32 v32, 16, v32
    v_mul_f32 v32, s54, v32
    v_cvt_pk_bf16_f32 v32, v32, v32
    v_lshlrev_b32 v32, 16, v32
    v_max_f32 v33, v34, v32
    ds_write_b32 v35, v32 offset:192
    v_sub_f32 v40, v34, v33
    v_sub_f32 v46, v32, v33
    v_mul_f32 v40, s55, v40
    v_mul_f32 v46, s55, v46
    v_exp_f32 v40, v40
    v_exp_f32 v46, v46
    v_mov_b32 v34, v33
    v_fma_f32 v36, v36, v40, v46
    v_mfma_f32_16x16x32_bf16 v[28:31], v[144:147], v[8:11], 0
    s_waitcnt vmcnt(4)
    buffer_load_dwordx4 v[88:91], v2, s[40:43], s44 offen offset:2048 nt
    v_mfma_f32_16x16x32_bf16 v[28:31], v[148:151], v[12:15], v[28:31]
    v_mfma_f32_16x16x32_bf16 v[28:31], v[152:155], v[16:19], v[28:31]
    s_nop 3
    s_nop 1
    v_cndmask_b32 v32, v24, v25, s[50:51]
    v_cndmask_b32 v33, v26, v27, s[50:51]
    v_cndmask_b32 v32, v32, v33, s[52:53]
    s_nop 1
    v_add_f32_dpp v32, v32, v32 quad_perm:[1,0,3,2] row_mask:0xf bank_mask:0xf
    s_nop 1
    v_add_f32_dpp v32, v32, v32 quad_perm:[2,3,0,1] row_mask:0xf bank_mask:0xf
    v_mfma_f32_16x16x32_bf16 v[28:31], v[156:159], v[20:23], v[28:31]
    v_cvt_pk_bf16_f32 v32, v32, v32
    v_lshlrev_b32 v32, 16, v32
    v_mul_f32 v32, s54, v32
    v_cvt_pk_bf16_f32 v32, v32, v32
    v_lshlrev_b32 v32, 16, v32
    v_max_f32 v33, v34, v32
    ds_write_b32 v35, v32 offset:256
    v_sub_f32 v40, v34, v33
    v_sub_f32 v46, v32, v33
    v_mul_f32 v40, s55, v40
    v_mul_f32 v46, s55, v46
    v_exp_f32 v40, v40
    v_exp_f32 v46, v46
    v_mov_b32 v34, v33
    v_fma_f32 v36, v36, v40, v46
    s_waitcnt vmcnt(4)
    buffer_load_dwordx4 v[92:95], v2, s[40:43], s44 offen offset:3072 nt
    s_add_u32 s44, s44, 16384
    v_mfma_f32_16x16x32_bf16 v[24:27], v[160:163], v[8:11], 0
    v_mfma_f32_16x16x32_bf16 v[24:27], v[164:167], v[12:15], v[24:27]
    v_mfma_f32_16x16x32_bf16 v[24:27], v[168:171], v[16:19], v[24:27]
    s_nop 3
    s_nop 1
    v_cndmask_b32 v32, v28, v29, s[50:51]
    v_cndmask_b32 v33, v30, v31, s[50:51]
    v_cndmask_b32 v32, v32, v33, s[52:53]
    s_nop 1
    v_add_f32_dpp v32, v32, v32 quad_perm:[1,0,3,2] row_mask:0xf bank_mask:0xf
    s_nop 1
    v_add_f32_dpp v32, v32, v32 quad_perm:[2,3,0,1] row_mask:0xf bank_mask:0xf
    s_waitcnt vmcnt(4)
    buffer_load_dwordx4 v[96:99], v2, s[40:43], s44 offen offset:0 nt
    v_mfma_f32_16x16x32_bf16 v[24:27], v[172:175], v[20:23], v[24:27]
    v_cvt_pk_bf16_f32 v32, v32, v32
    v_lshlrev_b32 v32, 16, v32
    v_mul_f32 v32, s54, v32
    v_cvt_pk_bf16_f32 v32, v32, v32
    v_lshlrev_b32 v32, 16, v32
    v_max_f32 v33, v34, v32
    ds_write_b32 v35, v32 offset:320
    v_sub_f32 v40, v34, v33
    v_sub_f32 v46, v32, v33
    v_mul_f32 v40, s55, v40
    v_mul_f32 v46, s55, v46
    v_exp_f32 v40, v40
    v_exp_f32 v46, v46
    v_mov_b32 v34, v33
    v_fma_f32 v36, v36, v40, v46
    v_mfma_f32_16x16x32_bf16 v[28:31], v[176:179], v[8:11], 0
    v_mfma_f32_16x16x32_bf16 v[28:31], v[180:183], v[12:15], v[28:31]
    s_waitcnt vmcnt(4)
    buffer_load_dwordx4 v[100:103], v2, s[40:43], s44 offen offset:1024 nt
    v_mfma_f32_16x16x32_bf16 v[28:31], v[184:187], v[16:19], v[28:31]
    s_nop 3
    s_nop 1
    v_cndmask_b32 v32, v24, v25, s[50:51]
    v_cndmask_b32 v33, v26, v27, s[50:51]
    v_cndmask_b32 v32, v32, v33, s[52:53]
    s_nop 1
    v_add_f32_dpp v32, v32, v32 quad_perm:[1,0,3,2] row_mask:0xf bank_mask:0xf
    s_nop 1
    v_add_f32_dpp v32, v32, v32 quad_perm:[2,3,0,1] row_mask:0xf bank_mask:0xf
    v_mfma_f32_16x16x32_bf16 v[28:31], v[188:191], v[20:23], v[28:31]
    v_cvt_pk_bf16_f32 v32, v32, v32
    v_lshlrev_b32 v32, 16, v32
    v_mul_f32 v32, s54, v32
    v_cvt_pk_bf16_f32 v32, v32, v32
    v_lshlrev_b32 v32, 16, v32
    v_max_f32 v33, v34, v32
    ds_write_b32 v35, v32 offset:384
    v_sub_f32 v40, v34, v33
    v_sub_f32 v46, v32, v33
    v_mul_f32 v40, s55, v40
    v_mul_f32 v46, s55, v46
    v_exp_f32 v40, v40
    v_exp_f32 v46, v46
    v_mov_b32 v34, v33
    v_fma_f32 v36, v36, v40, v46
    v_mfma_f32_16x16x32_bf16 v[24:27], v[192:195], v[8:11], 0
    s_waitcnt vmcnt(4)
    buffer_load_dwordx4 v[104:107], v2, s[40:43], s44 offen offset:2048 nt
    v_mfma_f32_16x16x32_bf16 v[24:27], v[196:199], v[12:15], v[24:27]
    v_mfma_f32_16x16x32_bf16 v[24:27], v[200:203], v[16:19], v[24:27]
    s_nop 3
    s_nop 1
    v_cndmask_b32 v32, v28, v29, s[50:51]
    v_cndmask_b32 v33, v30, v31, s[50:51]
    v_cndmask_b32 v32, v32, v33, s[52:53]
    s_nop 1
    v_add_f32_dpp v32, v32, v32 quad_perm:[1,0,3,2] row_mask:0xf bank_mask:0xf
    s_nop 1
    v_add_f32_dpp v32, v32, v32 quad_perm:[2,3,0,1] row_mask:0xf bank_mask:0xf
    v_mfma_f32_16x16x32_bf16 v[24:27], v[204:207], v[20:23], v[24:27]
    v_cvt_pk_bf16_f32 v32, v32, v32
    v_lshlrev_b32 v32, 16, v32
    v_mul_f32 v32, s54, v32
    v_cvt_pk_bf16_f32 v32, v32, v32
    v_lshlrev_b32 v32, 16, v32
    v_max_f32 v33, v34, v32
    ds_write_b32 v35, v32 offset:448
    v_sub_f32 v40, v34, v33
    v_sub_f32 v46, v32, v33
    v_mul_f32 v40, s55, v40
    v_mul_f32 v46, s55, v46
    v_exp_f32 v40, v40
    v_exp_f32 v46, v46
    v_mov_b32 v34, v33
    v_fma_f32 v36, v36, v40, v46
    s_waitcnt vmcnt(4)
    buffer_load_dwordx4 v[108:111], v2, s[40:43], s44 offen offset:3072 nt
    s_add_u32 s44, s44, 16384
    v_mfma_f32_16x16x32_bf16 v[28:31], v[208:211], v[8:11], 0
    v_mfma_f32_16x16x32_bf16 v[28:31], v[212:215], v[12:15], v[28:31]
    v_mfma_f32_16x16x32_bf16 v[28:31], v[216:219], v[16:19], v[28:31]
    s_nop 3
    s_nop 1
    v_cndmask_b32 v32, v24, v25, s[50:51]
    v_cndmask_b32 v33, v26, v27, s[50:51]
    v_cndmask_b32 v32, v32, v33, s[52:53]
    s_nop 1
    v_add_f32_dpp v32, v32, v32 quad_perm:[1,0,3,2] row_mask:0xf bank_mask:0xf
    s_nop 1
    v_add_f32_dpp v32, v32, v32 quad_perm:[2,3,0,1] row_mask:0xf bank_mask:0xf
    s_waitcnt vmcnt(4)
    buffer_load_dwordx4 v[112:115], v2, s[40:43], s44 offen offset:0 nt
    v_mfma_f32_16x16x32_bf16 v[28:31], v[220:223], v[20:23], v[28:31]
    v_cvt_pk_bf16_f32 v32, v32, v32
    v_lshlrev_b32 v32, 16, v32
    v_mul_f32 v32, s54, v32
    v_cvt_pk_bf16_f32 v32, v32, v32
    v_lshlrev_b32 v32, 16, v32
    v_max_f32 v33, v34, v32
    ds_write_b32 v35, v32 offset:512
    v_sub_f32 v40, v34, v33
    v_sub_f32 v46, v32, v33
    v_mul_f32 v40, s55, v40
    v_mul_f32 v46, s55, v46
    v_exp_f32 v40, v40
    v_exp_f32 v46, v46
    v_mov_b32 v34, v33
    v_fma_f32 v36, v36, v40, v46
    v_mfma_f32_16x16x32_bf16 v[24:27], v[224:227], v[8:11], 0
    v_mfma_f32_16x16x32_bf16 v[24:27], v[228:231], v[12:15], v[24:27]
    s_waitcnt vmcnt(4)
    buffer_load_dwordx4 v[116:119], v2, s[40:43], s44 offen offset:1024 nt
    s_waitcnt vmcnt(19)
    v_mfma_f32_16x16x32_bf16 v[24:27], v[232:235], v[16:19], v[24:27]
    s_nop 3
    s_nop 1
    v_cndmask_b32 v32, v28, v29, s[50:51]
    v_cndmask_b32 v33, v30, v31, s[50:51]
    v_cndmask_b32 v32, v32, v33, s[52:53]
    s_nop 1
    v_add_f32_dpp v32, v32, v32 quad_perm:[1,0,3,2] row_mask:0xf bank_mask:0xf
    s_nop 1
    v_add_f32_dpp v32, v32, v32 quad_perm:[2,3,0,1] row_mask:0xf bank_mask:0xf
    s_waitcnt vmcnt(18)
    v_mfma_f32_16x16x32_bf16 v[24:27], v[236:239], v[20:23], v[24:27]
    v_cvt_pk_bf16_f32 v32, v32, v32
    v_lshlrev_b32 v32, 16, v32
    v_mul_f32 v32, s54, v32
    v_cvt_pk_bf16_f32 v32, v32, v32
    v_lshlrev_b32 v32, 16, v32
    v_max_f32 v33, v34, v32
    ds_write_b32 v35, v32 offset:576
    v_sub_f32 v40, v34, v33
    v_sub_f32 v46, v32, v33
    v_mul_f32 v40, s55, v40
    v_mul_f32 v46, s55, v46
    v_exp_f32 v40, v40
    v_exp_f32 v46, v46
    v_mov_b32 v34, v33
    v_fma_f32 v36, v36, v40, v46
    s_waitcnt vmcnt(17)
    v_mfma_f32_16x16x32_bf16 v[28:31], v[240:243], v[8:11], 0
    s_waitcnt vmcnt(4)
    buffer_load_dwordx4 v[120:123], v2, s[40:43], s44 offen offset:2048 nt
    s_waitcnt vmcnt(17)
    v_mfma_f32_16x16x32_bf16 v[28:31], v[244:247], v[12:15], v[28:31]
    s_waitcnt vmcnt(16)
    v_mfma_f32_16x16x32_bf16 v[28:31], v[248:251], v[16:19], v[28:31]
    s_nop 3
    s_nop 1
    v_cndmask_b32 v32, v24, v25, s[50:51]
    v_cndmask_b32 v33, v26, v27, s[50:51]
    v_cndmask_b32 v32, v32, v33, s[52:53]
    s_nop 1
    v_add_f32_dpp v32, v32, v32 quad_perm:[1,0,3,2] row_mask:0xf bank_mask:0xf
    s_nop 1
    v_add_f32_dpp v32, v32, v32 quad_perm:[2,3,0,1] row_mask:0xf bank_mask:0xf
    s_waitcnt vmcnt(15)
    v_mfma_f32_16x16x32_bf16 v[28:31], v[252:255], v[20:23], v[28:31]
    v_cvt_pk_bf16_f32 v32, v32, v32
    v_lshlrev_b32 v32, 16, v32
    v_mul_f32 v32, s54, v32
    v_cvt_pk_bf16_f32 v32, v32, v32
    v_lshlrev_b32 v32, 16, v32
    v_max_f32 v33, v34, v32
    ds_write_b32 v35, v32 offset:640
    v_sub_f32 v40, v34, v33
    v_sub_f32 v46, v32, v33
    v_mul_f32 v40, s55, v40
    v_mul_f32 v46, s55, v46
    v_exp_f32 v40, v40
    v_exp_f32 v46, v46
    v_mov_b32 v34, v33
    v_fma_f32 v36, v36, v40, v46
    v_add_u32 v35, 704, v35
    s_mov_b32 s45, 0
L_kloop:
    s_waitcnt vmcnt(4)
    buffer_load_dwordx4 v[124:127], v2, s[40:43], s44 offen offset:3072 nt
    s_add_u32 s44, s44, 16384
    s_cmp_lg_u32 s45, 12
    s_cbranch_scc1 L_nosw
    s_mov_b32 s40, s48
    s_mov_b32 s41, s49
    s_lshl_b32 s44, s3, 12
    v_mov_b32 v2, v3
L_nosw:
    v_mfma_f32_16x16x32_bf16 v[24:27], v[64:67], v[8:11], 0
    s_waitcnt vmcnt(4)
    buffer_load_dwordx4 v[64:67], v2, s[40:43], s44 offen offset:0 nt
    v_mfma_f32_16x16x32_bf16 v[24:27], v[68:71], v[12:15], v[24:27]
    s_nop 1
    v_cndmask_b32 v32, v28, v29, s[50:51]
    v_cndmask_b32 v33, v30, v31, s[50:51]
    v_cndmask_b32 v32, v32, v33, s[52:53]
    s_nop 1
    v_add_f32_dpp v32, v32, v32 quad_perm:[1,0,3,2] row_mask:0xf bank_mask:0xf
    s_nop 1
    v_add_f32_dpp v32, v32, v32 quad_perm:[2,3,0,1] row_mask:0xf bank_mask:0xf
    s_waitcnt vmcnt(4)
    buffer_load_dwordx4 v[68:71], v2, s[40:43], s44 offen offset:1024 nt
    v_mfma_f32_16x16x32_bf16 v[24:27], v[72:75], v[16:19], v[24:27]
    v_cvt_pk_bf16_f32 v32, v32, v32
    v_lshlrev_b32 v32, 16, v32
    v_mul_f32 v32, s54, v32
    v_cvt_pk_bf16_f32 v32, v32, v32
    v_lshlrev_b32 v32, 16, v32
    v_max_f32 v33, v34, v32
    ds_write_b32 v35, v32 offset:0
    s_waitcnt vmcnt(4)
    buffer_load_dwordx4 v[72:75], v2, s[40:43], s44 offen offset:2048 nt
    v_mfma_f32_16x16x32_bf16 v[24:27], v[76:79], v[20:23], v[24:27]
    v_sub_f32 v40, v34, v33
    v_sub_f32 v46, v32, v33
    v_mul_f32 v40, s55, v40
    v_mul_f32 v46, s55, v46
    v_exp_f32 v40, v40
    v_exp_f32 v46, v46
    v_mov_b32 v34, v33
    v_fma_f32 v36, v36, v40, v46
    s_waitcnt vmcnt(4)
    buffer_load_dwordx4 v[76:79], v2, s[40:43], s44 offen offset:3072 nt
    s_add_u32 s44, s44, 16384
    v_mfma_f32_16x16x32_bf16 v[28:31], v[80:83], v[8:11], 0
    s_waitcnt vmcnt(4)
    buffer_load_dwordx4 v[80:83], v2, s[40:43], s44 offen offset:0 nt
    v_mfma_f32_16x16x32_bf16 v[28:31], v[84:87], v[12:15], v[28:31]
    s_nop 1
    v_cndmask_b32 v32, v24, v25, s[50:51]
    v_cndmask_b32 v33, v26, v27, s[50:51]
    v_cndmask_b32 v32, v32, v33, s[52:53]
    s_nop 1
    v_add_f32_dpp v32, v32, v32 quad_perm:[1,0,3,2] row_mask:0xf bank_mask:0xf
    s_nop 1
    v_add_f32_dpp v32, v32, v32 quad_perm:[2,3,0,1] row_mask:0xf bank_mask:0xf
    s_waitcnt vmcnt(4)
    buffer_load_dwordx4 v[84:87], v2, s[40:43], s44 offen offset:1024 nt
    v_mfma_f32_16x16x32_bf16 v[28:31], v[88:91], v[16:19], v[28:31]
    v_cvt_pk_bf16_f32 v32, v32, v32
    v_lshlrev_b32 v32, 16, v32
    v_mul_f32 v32, s54, v32
    v_cvt_pk_bf16_f32 v32, v32, v32
    v_lshlrev_b32 v32, 16, v32
    v_max_f32 v33, v34, v32
    ds_write_b32 v35, v32 offset:64
    s_waitcnt vmcnt(4)
    buffer_load_dwordx4 v[88:91], v2, s[40:43], s44 offen offset:2048 nt
    v_mfma_f32_16x16x32_bf16 v[28:31], v[92:95], v[20:23], v[28:31]
    v_sub_f32 v40, v34, v33
    v_sub_f32 v46, v32, v33
    v_mul_f32 v40, s55, v40
    v_mul_f32 v46, s55, v46
    v_exp_f32 v40, v40
    v_exp_f32 v46, v46
    v_mov_b32 v34, v33
    v_fma_f32 v36, v36, v40, v46
    s_waitcnt vmcnt(4)
    buffer_load_dwordx4 v[92:95], v2, s[40:43], s44 offen offset:3072 nt
    s_add_u32 s44, s44, 16384
    v_mfma_f32_16x16x32_bf16 v[24:27], v[96:99], v[8:11], 0
    s_waitcnt vmcnt(4)
    buffer_load_dwordx4 v[96:99], v2, s[40:43], s44 offen offset:0 nt
    v_mfma_f32_16x16x32_bf16 v[24:27], v[100:103], v[12:15], v[24:27]
    s_nop 1
    v_cndmask_b32 v32, v28, v29, s[50:51]
    v_cndmask_b32 v33, v30, v31, s[50:51]
    v_cndmask_b32 v32, v32, v33, s[52:53]
    s_nop 1
    v_add_f32_dpp v32, v32, v32 quad_perm:[1,0,3,2] row_mask:0xf bank_mask:0xf
    s_nop 1
    v_add_f32_dpp v32, v32, v32 quad_perm:[2,3,0,1] row_mask:0xf bank_mask:0xf
    s_waitcnt vmcnt(4)
    buffer_load_dwordx4 v[100:103], v2, s[40:43], s44 offen offset:1024 nt
    v_mfma_f32_16x16x32_bf16 v[24:27], v[104:107], v[16:19], v[24:27]
    v_cvt_pk_bf16_f32 v32, v32, v32
    v_lshlrev_b32 v32, 16, v32
    v_mul_f32 v32, s54, v32
    v_cvt_pk_bf16_f32 v32, v32, v32
    v_lshlrev_b32 v32, 16, v32
    v_max_f32 v33, v34, v32
    ds_write_b32 v35, v32 offset:128
    s_waitcnt vmcnt(4)
    buffer_load_dwordx4 v[104:107], v2, s[40:43], s44 offen offset:2048 nt
    v_mfma_f32_16x16x32_bf16 v[24:27], v[108:111], v[20:23], v[24:27]
    v_sub_f32 v40, v34, v33
    v_sub_f32 v46, v32, v33
    v_mul_f32 v40, s55, v40
    v_mul_f32 v46, s55, v46
    v_exp_f32 v40, v40
    v_exp_f32 v46, v46
    v_mov_b32 v34, v33
    v_fma_f32 v36, v36, v40, v46
    s_waitcnt vmcnt(4)
    buffer_load_dwordx4 v[108:111], v2, s[40:43], s44 offen offset:3072 nt
    s_add_u32 s44, s44, 16384
    v_mfma_f32_16x16x32_bf16 v[28:31], v[112:115], v[8:11], 0
    s_waitcnt vmcnt(4)
    buffer_load_dwordx4 v[112:115], v2, s[40:43], s44 offen offset:0 nt
    v_mfma_f32_16x16x32_bf16 v[28:31], v[116:119], v[12:15], v[28:31]
    s_nop 1
    v_cndmask_b32 v32, v24, v25, s[50:51]
    v_cndmask_b32 v33, v26, v27, s[50:51]
    v_cndmask_b32 v32, v32, v33, s[52:53]
    s_nop 1
    v_add_f32_dpp v32, v32, v32 quad_perm:[1,0,3,2] row_mask:0xf bank_mask:0xf
    s_nop 1
    v_add_f32_dpp v32, v32, v32 quad_perm:[2,3,0,1] row_mask:0xf bank_mask:0xf
    s_waitcnt vmcnt(4)
    buffer_load_dwordx4 v[116:119], v2, s[40:43], s44 offen offset:1024 nt
    v_mfma_f32_16x16x32_bf16 v[28:31], v[120:123], v[16:19], v[28:31]
    v_cvt_pk_bf16_f32 v32, v32, v32
    v_lshlrev_b32 v32, 16, v32
    v_mul_f32 v32, s54, v32
    v_cvt_pk_bf16_f32 v32, v32, v32
    v_lshlrev_b32 v32, 16, v32
    v_max_f32 v33, v34, v32
    ds_write_b32 v35, v32 offset:192
    s_waitcnt vmcnt(4)
    buffer_load_dwordx4 v[120:123], v2, s[40:43], s44 offen offset:2048 nt
    v_mfma_f32_16x16x32_bf16 v[28:31], v[124:127], v[20:23], v[28:31]
    v_sub_f32 v40, v34, v33
    v_sub_f32 v46, v32, v33
    v_mul_f32 v40, s55, v40
    v_mul_f32 v46, s55, v46
    v_exp_f32 v40, v40
    v_exp_f32 v46, v46
    v_mov_b32 v34, v33
    v_fma_f32 v36, v36, v40, v46
    v_add_u32 v35, 256, v35
    s_add_u32 s45, s45, 1
    s_cmp_lt_u32 s45, 13
    s_cbranch_scc1 L_kloop
    s_waitcnt vmcnt(4)
    buffer_load_dwordx4 v[124:127], v2, s[40:43], s44 offen offset:3072 nt
    s_add_u32 s44, s44, 16384
    s_nop 1
    v_cndmask_b32 v32, v28, v29, s[50:51]
    v_cndmask_b32 v33, v30, v31, s[50:51]
    v_cndmask_b32 v32, v32, v33, s[52:53]
    s_nop 1
    v_add_f32_dpp v32, v32, v32 quad_perm:[1,0,3,2] row_mask:0xf bank_mask:0xf
    s_nop 1
    v_add_f32_dpp v32, v32, v32 quad_perm:[2,3,0,1] row_mask:0xf bank_mask:0xf
    v_cvt_pk_bf16_f32 v32, v32, v32
    v_lshlrev_b32 v32, 16, v32
    v_mul_f32 v32, s54, v32
    v_cvt_pk_bf16_f32 v32, v32, v32
    v_lshlrev_b32 v32, 16, v32
    v_max_f32 v33, v34, v32
    ds_write_b32 v35, v32 offset:0
    v_sub_f32 v40, v34, v33
    v_sub_f32 v46, v32, v33
    v_mul_f32 v40, s55, v40
    v_mul_f32 v46, s55, v46
    v_exp_f32 v40, v40
    v_exp_f32 v46, v46
    v_mov_b32 v34, v33
    v_fma_f32 v36, v36, v40, v46
    s_waitcnt vmcnt(4)
    buffer_load_dwordx4 v[128:131], v2, s[40:43], s44 offen offset:0 nt
    s_nop 0
    v_max_f32_dpp v33, v34, v34 row_ror:4 row_mask:0xf bank_mask:0xf
    v_subrev_u32 v35, 4032, v35
    v_mov_b32 v28, 0
    v_max_f32_dpp v33, v33, v33 row_ror:8 row_mask:0xf bank_mask:0xf
    v_mov_b32 v29, 0
    v_readlane_b32 s56, v33, 0
    v_readlane_b32 s57, v33, 16
    v_readlane_b32 s58, v33, 32
    v_readlane_b32 s59, v33, 48
    v_mov_b32 v30, 0
    v_mov_b32 v48, s56
    v_max_f32 v48, s57, v48
    v_max_f32 v48, s58, v48
    v_max_f32 v48, s59, v48
    v_sub_f32 v40, v34, v48
    v_mul_f32 v40, s55, v40
    v_exp_f32 v40, v40
    v_mov_b32 v31, 0
    v_mul_f32 v36, v36, v40
    v_mov_b32 v50, 1
    v_mov_b32 v51, 1
    v_add_f32_dpp v36, v36, v36 row_ror:4 row_mask:0xf bank_mask:0xf
    s_nop 1
    v_add_f32_dpp v36, v36, v36 row_ror:8 row_mask:0xf bank_mask:0xf
    s_nop 0
    v_readlane_b32 s56, v36, 0
    v_readlane_b32 s57, v36, 16
    v_readlane_b32 s58, v36, 32
    v_readlane_b32 s59, v36, 48
    v_mov_b32 v33, 0
    v_mov_b32 v49, s56
    v_add_f32 v49, s57, v49
    v_add_f32 v49, s58, v49
    v_add_f32 v49, s59, v49
    ds_write_b128 v61, v[48:51] offset:9216
    s_waitcnt vmcnt(4)
    buffer_load_dwordx4 v[132:135], v2, s[40:43], s44 offen offset:1024 nt
    s_mov_b32 s64, 524288
L_stw:
    ds_read_b128 v[8:11], v33 offset:9216
    ds_read_b128 v[12:15], v33 offset:9232
    ds_read_b128 v[16:19], v33 offset:9248
    ds_read_b128 v[20:23], v33 offset:9264
    ds_read_b32 v39, v35
    s_waitcnt lgkmcnt(0)
    v_and_b32 v40, v10, v14
    v_and_b32 v46, v18, v22
    v_and_b32 v40, v40, v46
    s_nop 0
    v_readfirstlane_b32 s7, v40
    s_cmp_lg_u32 s7, 0
    s_cbranch_scc1 L_stwd
    s_sub_u32 s64, s64, 1
    s_cbranch_scc0 L_stw
L_stwd:
    s_waitcnt vmcnt(4)
    buffer_load_dwordx4 v[136:139], v2, s[40:43], s44 offen offset:2048 nt
    v_max_f32 v41, v8, v12
    v_max3_f32 v41, v41, v16, v20
    v_sub_f32 v8, v8, v41
    v_sub_f32 v12, v12, v41
    v_sub_f32 v16, v16, v41
    v_sub_f32 v20, v20, v41
    v_mul_f32 v8, s55, v8
    v_mul_f32 v12, s55, v12
    v_mul_f32 v16, s55, v16
    v_mul_f32 v20, s55, v20
    v_exp_f32 v8, v8
    v_exp_f32 v12, v12
    v_exp_f32 v16, v16
    v_exp_f32 v20, v20
    v_mul_f32 v40, v8, v9
    v_fmac_f32 v40, v12, v13
    v_fmac_f32 v40, v16, v17
    v_fmac_f32 v40, v20, v21
    v_rcp_f32 v47, v40
    s_nop 0
    v_fma_f32 v46, -v40, v47, 1.0
    v_fmac_f32 v47, v46, v47
    s_waitcnt lgkmcnt(0)
    v_sub_f32 v39, v39, v41
    v_mul_f32 v39, s55, v39
    v_exp_f32 v39, v39
    s_nop 0
    v_mul_f32 v39, v39, v47
    v_cvt_pk_bf16_f32 v37, v39, v39
    s_nop 0
    s_mov_b32 s45, 0
L_vloop:
    s_waitcnt vmcnt(4)
    buffer_load_dwordx4 v[140:143], v2, s[40:43], s44 offen offset:3072 nt
    s_add_u32 s44, s44, 16384
    ds_read_b32 v39, v35 offset:64
    v_and_b32_dpp v24, v37, v4 row_newbcast:0 row_mask:0xf bank_mask:0xf
    v_and_b32_dpp v25, v37, v5 row_newbcast:0 row_mask:0xf bank_mask:0xf
    v_and_b32_dpp v26, v37, v6 row_newbcast:0 row_mask:0xf bank_mask:0xf
    v_and_b32_dpp v27, v37, v7 row_newbcast:0 row_mask:0xf bank_mask:0xf
    s_nop 1
    v_mfma_f32_16x16x32_bf16 v[28:31], v[24:27], v[64:67], v[28:31]
    s_waitcnt vmcnt(4)
    buffer_load_dwordx4 v[144:147], v2, s[40:43], s44 offen offset:0 nt
    v_and_b32_dpp v24, v37, v4 row_newbcast:4 row_mask:0xf bank_mask:0xf
    v_and_b32_dpp v25, v37, v5 row_newbcast:4 row_mask:0xf bank_mask:0xf
    v_and_b32_dpp v26, v37, v6 row_newbcast:4 row_mask:0xf bank_mask:0xf
    v_and_b32_dpp v27, v37, v7 row_newbcast:4 row_mask:0xf bank_mask:0xf
    s_nop 1
    v_mfma_f32_16x16x32_bf16 v[28:31], v[24:27], v[68:71], v[28:31]
    s_waitcnt vmcnt(4)
    buffer_load_dwordx4 v[148:151], v2, s[40:43], s44 offen offset:1024 nt
    v_and_b32_dpp v24, v37, v4 row_newbcast:8 row_mask:0xf bank_mask:0xf
    v_and_b32_dpp v25, v37, v5 row_newbcast:8 row_mask:0xf bank_mask:0xf
    v_and_b32_dpp v26, v37, v6 row_newbcast:8 row_mask:0xf bank_mask:0xf
    v_and_b32_dpp v27, v37, v7 row_newbcast:8 row_mask:0xf bank_mask:0xf
    s_nop 1
    v_mfma_f32_16x16x32_bf16 v[28:31], v[24:27], v[72:75], v[28:31]
    s_waitcnt lgkmcnt(0)
    v_sub_f32 v39, v39, v41
    v_mul_f32 v39, s55, v39
    v_exp_f32 v39, v39
    s_nop 0
    v_mul_f32 v39, v39, v47
    v_cvt_pk_bf16_f32 v38, v39, v39
    s_waitcnt vmcnt(4)
    buffer_load_dwordx4 v[152:155], v2, s[40:43], s44 offen offset:2048 nt
    v_and_b32_dpp v24, v37, v4 row_newbcast:12 row_mask:0xf bank_mask:0xf
    v_and_b32_dpp v25, v37, v5 row_newbcast:12 row_mask:0xf bank_mask:0xf
    v_and_b32_dpp v26, v37, v6 row_newbcast:12 row_mask:0xf bank_mask:0xf
    v_and_b32_dpp v27, v37, v7 row_newbcast:12 row_mask:0xf bank_mask:0xf
    s_nop 1
    v_mfma_f32_16x16x32_bf16 v[28:31], v[24:27], v[76:79], v[28:31]
    s_waitcnt vmcnt(4)
    buffer_load_dwordx4 v[156:159], v2, s[40:43], s44 offen offset:3072 nt
    s_add_u32 s44, s44, 16384
    ds_read_b32 v39, v35 offset:128
    v_and_b32_dpp v24, v38, v4 row_newbcast:0 row_mask:0xf bank_mask:0xf
    v_and_b32_dpp v25, v38, v5 row_newbcast:0 row_mask:0xf bank_mask:0xf
    v_and_b32_dpp v26, v38, v6 row_newbcast:0 row_mask:0xf bank_mask:0xf
    v_and_b32_dpp v27, v38, v7 row_newbcast:0 row_mask:0xf bank_mask:0xf
    s_nop 1
    v_mfma_f32_16x16x32_bf16 v[28:31], v[24:27], v[80:83], v[28:31]
    s_waitcnt vmcnt(4)
    buffer_load_dwordx4 v[160:163], v2, s[40:43], s44 offen offset:0 nt
    v_and_b32_dpp v24, v38, v4 row_newbcast:4 row_mask:0xf bank_mask:0xf
    v_and_b32_dpp v25, v38, v5 row_newbcast:4 row_mask:0xf bank_mask:0xf
    v_and_b32_dpp v26, v38, v6 row_newbcast:4 row_mask:0xf bank_mask:0xf
    v_and_b32_dpp v27, v38, v7 row_newbcast:4 row_mask:0xf bank_mask:0xf
    s_nop 1
    v_mfma_f32_16x16x32_bf16 v[28:31], v[24:27], v[84:87], v[28:31]
    s_waitcnt vmcnt(4)
    buffer_load_dwordx4 v[164:167], v2, s[40:43], s44 offen offset:1024 nt
    v_and_b32_dpp v24, v38, v4 row_newbcast:8 row_mask:0xf bank_mask:0xf
    v_and_b32_dpp v25, v38, v5 row_newbcast:8 row_mask:0xf bank_mask:0xf
    v_and_b32_dpp v26, v38, v6 row_newbcast:8 row_mask:0xf bank_mask:0xf
    v_and_b32_dpp v27, v38, v7 row_newbcast:8 row_mask:0xf bank_mask:0xf
    s_nop 1
    v_mfma_f32_16x16x32_bf16 v[28:31], v[24:27], v[88:91], v[28:31]
    s_waitcnt lgkmcnt(0)
    v_sub_f32 v39, v39, v41
    v_mul_f32 v39, s55, v39
    v_exp_f32 v39, v39
    s_nop 0
    v_mul_f32 v39, v39, v47
    v_cvt_pk_bf16_f32 v37, v39, v39
    s_waitcnt vmcnt(4)
    buffer_load_dwordx4 v[168:171], v2, s[40:43], s44 offen offset:2048 nt
    v_and_b32_dpp v24, v38, v4 row_newbcast:12 row_mask:0xf bank_mask:0xf
    v_and_b32_dpp v25, v38, v5 row_newbcast:12 row_mask:0xf bank_mask:0xf
    v_and_b32_dpp v26, v38, v6 row_newbcast:12 row_mask:0xf bank_mask:0xf
    v_and_b32_dpp v27, v38, v7 row_newbcast:12 row_mask:0xf bank_mask:0xf
    s_nop 1
    v_mfma_f32_16x16x32_bf16 v[28:31], v[24:27], v[92:95], v[28:31]
    s_waitcnt vmcnt(4)
    buffer_load_dwordx4 v[172:175], v2, s[40:43], s44 offen offset:3072 nt
    s_add_u32 s44, s44, 16384
    ds_read_b32 v39, v35 offset:192
    v_and_b32_dpp v24, v37, v4 row_newbcast:0 row_mask:0xf bank_mask:0xf
    v_and_b32_dpp v25, v37, v5 row_newbcast:0 row_mask:0xf bank_mask:0xf
    v_and_b32_dpp v26, v37, v6 row_newbcast:0 row_mask:0xf bank_mask:0xf
    v_and_b32_dpp v27, v37, v7 row_newbcast:0 row_mask:0xf bank_mask:0xf
    s_nop 1
    v_mfma_f32_16x16x32_bf16 v[28:31], v[24:27], v[96:99], v[28:31]
    s_waitcnt vmcnt(4)
    buffer_load_dwordx4 v[176:179], v2, s[40:43], s44 offen offset:0 nt
    v_and_b32_dpp v24, v37, v4 row_newbcast:4 row_mask:0xf bank_mask:0xf
    v_and_b32_dpp v25, v37, v5 row_newbcast:4 row_mask:0xf bank_mask:0xf
    v_and_b32_dpp v26, v37, v6 row_newbcast:4 row_mask:0xf bank_mask:0xf
    v_and_b32_dpp v27, v37, v7 row_newbcast:4 row_mask:0xf bank_mask:0xf
    s_nop 1
    v_mfma_f32_16x16x32_bf16 v[28:31], v[24:27], v[100:103], v[28:31]
    s_waitcnt vmcnt(4)
    buffer_load_dwordx4 v[180:183], v2, s[40:43], s44 offen offset:1024 nt
    v_and_b32_dpp v24, v37, v4 row_newbcast:8 row_mask:0xf bank_mask:0xf
    v_and_b32_dpp v25, v37, v5 row_newbcast:8 row_mask:0xf bank_mask:0xf
    v_and_b32_dpp v26, v37, v6 row_newbcast:8 row_mask:0xf bank_mask:0xf
    v_and_b32_dpp v27, v37, v7 row_newbcast:8 row_mask:0xf bank_mask:0xf
    s_nop 1
    v_mfma_f32_16x16x32_bf16 v[28:31], v[24:27], v[104:107], v[28:31]
    s_waitcnt lgkmcnt(0)
    v_sub_f32 v39, v39, v41
    v_mul_f32 v39, s55, v39
    v_exp_f32 v39, v39
    s_nop 0
    v_mul_f32 v39, v39, v47
    v_cvt_pk_bf16_f32 v38, v39, v39
    s_waitcnt vmcnt(4)
    buffer_load_dwordx4 v[184:187], v2, s[40:43], s44 offen offset:2048 nt
    v_and_b32_dpp v24, v37, v4 row_newbcast:12 row_mask:0xf bank_mask:0xf
    v_and_b32_dpp v25, v37, v5 row_newbcast:12 row_mask:0xf bank_mask:0xf
    v_and_b32_dpp v26, v37, v6 row_newbcast:12 row_mask:0xf bank_mask:0xf
    v_and_b32_dpp v27, v37, v7 row_newbcast:12 row_mask:0xf bank_mask:0xf
    s_nop 1
    v_mfma_f32_16x16x32_bf16 v[28:31], v[24:27], v[108:111], v[28:31]
    s_waitcnt vmcnt(4)
    buffer_load_dwordx4 v[188:191], v2, s[40:43], s44 offen offset:3072 nt
    s_add_u32 s44, s44, 16384
    ds_read_b32 v39, v35 offset:256
    v_and_b32_dpp v24, v38, v4 row_newbcast:0 row_mask:0xf bank_mask:0xf
    v_and_b32_dpp v25, v38, v5 row_newbcast:0 row_mask:0xf bank_mask:0xf
    v_and_b32_dpp v26, v38, v6 row_newbcast:0 row_mask:0xf bank_mask:0xf
    v_and_b32_dpp v27, v38, v7 row_newbcast:0 row_mask:0xf bank_mask:0xf
    s_nop 1
    v_mfma_f32_16x16x32_bf16 v[28:31], v[24:27], v[112:115], v[28:31]
    s_waitcnt vmcnt(4)
    buffer_load_dwordx4 v[64:67], v2, s[40:43], s44 offen offset:0 nt
    v_and_b32_dpp v24, v38, v4 row_newbcast:4 row_mask:0xf bank_mask:0xf
    v_and_b32_dpp v25, v38, v5 row_newbcast:4 row_mask:0xf bank_mask:0xf
    v_and_b32_dpp v26, v38, v6 row_newbcast:4 row_mask:0xf bank_mask:0xf
    v_and_b32_dpp v27, v38, v7 row_newbcast:4 row_mask:0xf bank_mask:0xf
    s_nop 1
    v_mfma_f32_16x16x32_bf16 v[28:31], v[24:27], v[116:119], v[28:31]
    s_waitcnt vmcnt(4)
    buffer_load_dwordx4 v[68:71], v2, s[40:43], s44 offen offset:1024 nt
    v_and_b32_dpp v24, v38, v4 row_newbcast:8 row_mask:0xf bank_mask:0xf
    v_and_b32_dpp v25, v38, v5 row_newbcast:8 row_mask:0xf bank_mask:0xf
    v_and_b32_dpp v26, v38, v6 row_newbcast:8 row_mask:0xf bank_mask:0xf
    v_and_b32_dpp v27, v38, v7 row_newbcast:8 row_mask:0xf bank_mask:0xf
    s_nop 1
    v_mfma_f32_16x16x32_bf16 v[28:31], v[24:27], v[120:123], v[28:31]
    s_waitcnt lgkmcnt(0)
    v_sub_f32 v39, v39, v41
    v_mul_f32 v39, s55, v39
    v_exp_f32 v39, v39
    s_nop 0
    v_mul_f32 v39, v39, v47
    v_cvt_pk_bf16_f32 v37, v39, v39
    s_waitcnt vmcnt(4)
    buffer_load_dwordx4 v[72:75], v2, s[40:43], s44 offen offset:2048 nt
    v_and_b32_dpp v24, v38, v4 row_newbcast:12 row_mask:0xf bank_mask:0xf
    v_and_b32_dpp v25, v38, v5 row_newbcast:12 row_mask:0xf bank_mask:0xf
    v_and_b32_dpp v26, v38, v6 row_newbcast:12 row_mask:0xf bank_mask:0xf
    v_and_b32_dpp v27, v38, v7 row_newbcast:12 row_mask:0xf bank_mask:0xf
    s_nop 1
    v_mfma_f32_16x16x32_bf16 v[28:31], v[24:27], v[124:127], v[28:31]
    s_waitcnt vmcnt(4)
    buffer_load_dwordx4 v[76:79], v2, s[40:43], s44 offen offset:3072 nt
    s_add_u32 s44, s44, 16384
    ds_read_b32 v39, v35 offset:320
    v_and_b32_dpp v24, v37, v4 row_newbcast:0 row_mask:0xf bank_mask:0xf
    v_and_b32_dpp v25, v37, v5 row_newbcast:0 row_mask:0xf bank_mask:0xf
    v_and_b32_dpp v26, v37, v6 row_newbcast:0 row_mask:0xf bank_mask:0xf
    v_and_b32_dpp v27, v37, v7 row_newbcast:0 row_mask:0xf bank_mask:0xf
    s_nop 1
    v_mfma_f32_16x16x32_bf16 v[28:31], v[24:27], v[128:131], v[28:31]
    s_waitcnt vmcnt(4)
    buffer_load_dwordx4 v[80:83], v2, s[40:43], s44 offen offset:0 nt
    v_and_b32_dpp v24, v37, v4 row_newbcast:4 row_mask:0xf bank_mask:0xf
    v_and_b32_dpp v25, v37, v5 row_newbcast:4 row_mask:0xf bank_mask:0xf
    v_and_b32_dpp v26, v37, v6 row_newbcast:4 row_mask:0xf bank_mask:0xf
    v_and_b32_dpp v27, v37, v7 row_newbcast:4 row_mask:0xf bank_mask:0xf
    s_nop 1
    v_mfma_f32_16x16x32_bf16 v[28:31], v[24:27], v[132:135], v[28:31]
    s_waitcnt vmcnt(4)
    buffer_load_dwordx4 v[84:87], v2, s[40:43], s44 offen offset:1024 nt
    v_and_b32_dpp v24, v37, v4 row_newbcast:8 row_mask:0xf bank_mask:0xf
    v_and_b32_dpp v25, v37, v5 row_newbcast:8 row_mask:0xf bank_mask:0xf
    v_and_b32_dpp v26, v37, v6 row_newbcast:8 row_mask:0xf bank_mask:0xf
    v_and_b32_dpp v27, v37, v7 row_newbcast:8 row_mask:0xf bank_mask:0xf
    s_nop 1
    v_mfma_f32_16x16x32_bf16 v[28:31], v[24:27], v[136:139], v[28:31]
    s_waitcnt lgkmcnt(0)
    v_sub_f32 v39, v39, v41
    v_mul_f32 v39, s55, v39
    v_exp_f32 v39, v39
    s_nop 0
    v_mul_f32 v39, v39, v47
    v_cvt_pk_bf16_f32 v38, v39, v39
    s_waitcnt vmcnt(4)
    buffer_load_dwordx4 v[88:91], v2, s[40:43], s44 offen offset:2048 nt
    v_and_b32_dpp v24, v37, v4 row_newbcast:12 row_mask:0xf bank_mask:0xf
    v_and_b32_dpp v25, v37, v5 row_newbcast:12 row_mask:0xf bank_mask:0xf
    v_and_b32_dpp v26, v37, v6 row_newbcast:12 row_mask:0xf bank_mask:0xf
    v_and_b32_dpp v27, v37, v7 row_newbcast:12 row_mask:0xf bank_mask:0xf
    s_nop 1
    v_mfma_f32_16x16x32_bf16 v[28:31], v[24:27], v[140:143], v[28:31]
    s_waitcnt vmcnt(4)
    buffer_load_dwordx4 v[92:95], v2, s[40:43], s44 offen offset:3072 nt
    s_add_u32 s44, s44, 16384
    ds_read_b32 v39, v35 offset:384
    v_and_b32_dpp v24, v38, v4 row_newbcast:0 row_mask:0xf bank_mask:0xf
    v_and_b32_dpp v25, v38, v5 row_newbcast:0 row_mask:0xf bank_mask:0xf
    v_and_b32_dpp v26, v38, v6 row_newbcast:0 row_mask:0xf bank_mask:0xf
    v_and_b32_dpp v27, v38, v7 row_newbcast:0 row_mask:0xf bank_mask:0xf
    s_nop 1
    v_mfma_f32_16x16x32_bf16 v[28:31], v[24:27], v[144:147], v[28:31]
    s_waitcnt vmcnt(4)
    buffer_load_dwordx4 v[96:99], v2, s[40:43], s44 offen offset:0 nt
    v_and_b32_dpp v24, v38, v4 row_newbcast:4 row_mask:0xf bank_mask:0xf
    v_and_b32_dpp v25, v38, v5 row_newbcast:4 row_mask:0xf bank_mask:0xf
    v_and_b32_dpp v26, v38, v6 row_newbcast:4 row_mask:0xf bank_mask:0xf
    v_and_b32_dpp v27, v38, v7 row_newbcast:4 row_mask:0xf bank_mask:0xf
    s_nop 1
    v_mfma_f32_16x16x32_bf16 v[28:31], v[24:27], v[148:151], v[28:31]
    s_waitcnt vmcnt(4)
    buffer_load_dwordx4 v[100:103], v2, s[40:43], s44 offen offset:1024 nt
    v_and_b32_dpp v24, v38, v4 row_newbcast:8 row_mask:0xf bank_mask:0xf
    v_and_b32_dpp v25, v38, v5 row_newbcast:8 row_mask:0xf bank_mask:0xf
    v_and_b32_dpp v26, v38, v6 row_newbcast:8 row_mask:0xf bank_mask:0xf
    v_and_b32_dpp v27, v38, v7 row_newbcast:8 row_mask:0xf bank_mask:0xf
    s_nop 1
    v_mfma_f32_16x16x32_bf16 v[28:31], v[24:27], v[152:155], v[28:31]
    s_waitcnt lgkmcnt(0)
    v_sub_f32 v39, v39, v41
    v_mul_f32 v39, s55, v39
    v_exp_f32 v39, v39
    s_nop 0
    v_mul_f32 v39, v39, v47
    v_cvt_pk_bf16_f32 v37, v39, v39
    s_waitcnt vmcnt(4)
    buffer_load_dwordx4 v[104:107], v2, s[40:43], s44 offen offset:2048 nt
    v_and_b32_dpp v24, v38, v4 row_newbcast:12 row_mask:0xf bank_mask:0xf
    v_and_b32_dpp v25, v38, v5 row_newbcast:12 row_mask:0xf bank_mask:0xf
    v_and_b32_dpp v26, v38, v6 row_newbcast:12 row_mask:0xf bank_mask:0xf
    v_and_b32_dpp v27, v38, v7 row_newbcast:12 row_mask:0xf bank_mask:0xf
    s_nop 1
    v_mfma_f32_16x16x32_bf16 v[28:31], v[24:27], v[156:159], v[28:31]
    s_waitcnt vmcnt(4)
    buffer_load_dwordx4 v[108:111], v2, s[40:43], s44 offen offset:3072 nt
    s_add_u32 s44, s44, 16384
    ds_read_b32 v39, v35 offset:448
    v_and_b32_dpp v24, v37, v4 row_newbcast:0 row_mask:0xf bank_mask:0xf
    v_and_b32_dpp v25, v37, v5 row_newbcast:0 row_mask:0xf bank_mask:0xf
    v_and_b32_dpp v26, v37, v6 row_newbcast:0 row_mask:0xf bank_mask:0xf
    v_and_b32_dpp v27, v37, v7 row_newbcast:0 row_mask:0xf bank_mask:0xf
    s_nop 1
    v_mfma_f32_16x16x32_bf16 v[28:31], v[24:27], v[160:163], v[28:31]
    s_waitcnt vmcnt(4)
    buffer_load_dwordx4 v[112:115], v2, s[40:43], s44 offen offset:0 nt
    v_and_b32_dpp v24, v37, v4 row_newbcast:4 row_mask:0xf bank_mask:0xf
    v_and_b32_dpp v25, v37, v5 row_newbcast:4 row_mask:0xf bank_mask:0xf
    v_and_b32_dpp v26, v37, v6 row_newbcast:4 row_mask:0xf bank_mask:0xf
    v_and_b32_dpp v27, v37, v7 row_newbcast:4 row_mask:0xf bank_mask:0xf
    s_nop 1
    v_mfma_f32_16x16x32_bf16 v[28:31], v[24:27], v[164:167], v[28:31]
    s_waitcnt vmcnt(4)
    buffer_load_dwordx4 v[116:119], v2, s[40:43], s44 offen offset:1024 nt
    v_and_b32_dpp v24, v37, v4 row_newbcast:8 row_mask:0xf bank_mask:0xf
    v_and_b32_dpp v25, v37, v5 row_newbcast:8 row_mask:0xf bank_mask:0xf
    v_and_b32_dpp v26, v37, v6 row_newbcast:8 row_mask:0xf bank_mask:0xf
    v_and_b32_dpp v27, v37, v7 row_newbcast:8 row_mask:0xf bank_mask:0xf
    s_nop 1
    v_mfma_f32_16x16x32_bf16 v[28:31], v[24:27], v[168:171], v[28:31]
    s_waitcnt lgkmcnt(0)
    v_sub_f32 v39, v39, v41
    v_mul_f32 v39, s55, v39
    v_exp_f32 v39, v39
    s_nop 0
    v_mul_f32 v39, v39, v47
    v_cvt_pk_bf16_f32 v38, v39, v39
    s_waitcnt vmcnt(4)
    buffer_load_dwordx4 v[120:123], v2, s[40:43], s44 offen offset:2048 nt
    v_and_b32_dpp v24, v37, v4 row_newbcast:12 row_mask:0xf bank_mask:0xf
    v_and_b32_dpp v25, v37, v5 row_newbcast:12 row_mask:0xf bank_mask:0xf
    v_and_b32_dpp v26, v37, v6 row_newbcast:12 row_mask:0xf bank_mask:0xf
    v_and_b32_dpp v27, v37, v7 row_newbcast:12 row_mask:0xf bank_mask:0xf
    s_nop 1
    v_mfma_f32_16x16x32_bf16 v[28:31], v[24:27], v[172:175], v[28:31]
    s_waitcnt vmcnt(4)
    buffer_load_dwordx4 v[124:127], v2, s[40:43], s44 offen offset:3072 nt
    s_add_u32 s44, s44, 16384
    ds_read_b32 v39, v35 offset:512
    v_and_b32_dpp v24, v38, v4 row_newbcast:0 row_mask:0xf bank_mask:0xf
    v_and_b32_dpp v25, v38, v5 row_newbcast:0 row_mask:0xf bank_mask:0xf
    v_and_b32_dpp v26, v38, v6 row_newbcast:0 row_mask:0xf bank_mask:0xf
    v_and_b32_dpp v27, v38, v7 row_newbcast:0 row_mask:0xf bank_mask:0xf
    s_nop 1
    v_mfma_f32_16x16x32_bf16 v[28:31], v[24:27], v[176:179], v[28:31]
    s_waitcnt vmcnt(4)
    buffer_load_dwordx4 v[128:131], v2, s[40:43], s44 offen offset:0 nt
    v_and_b32_dpp v24, v38, v4 row_newbcast:4 row_mask:0xf bank_mask:0xf
    v_and_b32_dpp v25, v38, v5 row_newbcast:4 row_mask:0xf bank_mask:0xf
    v_and_b32_dpp v26, v38, v6 row_newbcast:4 row_mask:0xf bank_mask:0xf
    v_and_b32_dpp v27, v38, v7 row_newbcast:4 row_mask:0xf bank_mask:0xf
    s_nop 1
    v_mfma_f32_16x16x32_bf16 v[28:31], v[24:27], v[180:183], v[28:31]
    s_waitcnt vmcnt(4)
    buffer_load_dwordx4 v[132:135], v2, s[40:43], s44 offen offset:1024 nt
    v_and_b32_dpp v24, v38, v4 row_newbcast:8 row_mask:0xf bank_mask:0xf
    v_and_b32_dpp v25, v38, v5 row_newbcast:8 row_mask:0xf bank_mask:0xf
    v_and_b32_dpp v26, v38, v6 row_newbcast:8 row_mask:0xf bank_mask:0xf
    v_and_b32_dpp v27, v38, v7 row_newbcast:8 row_mask:0xf bank_mask:0xf
    s_nop 1
    v_mfma_f32_16x16x32_bf16 v[28:31], v[24:27], v[184:187], v[28:31]
    s_waitcnt lgkmcnt(0)
    v_sub_f32 v39, v39, v41
    v_mul_f32 v39, s55, v39
    v_exp_f32 v39, v39
    s_nop 0
    v_mul_f32 v39, v39, v47
    v_cvt_pk_bf16_f32 v37, v39, v39
    s_waitcnt vmcnt(4)
    buffer_load_dwordx4 v[136:139], v2, s[40:43], s44 offen offset:2048 nt
    v_and_b32_dpp v24, v38, v4 row_newbcast:12 row_mask:0xf bank_mask:0xf
    v_and_b32_dpp v25, v38, v5 row_newbcast:12 row_mask:0xf bank_mask:0xf
    v_and_b32_dpp v26, v38, v6 row_newbcast:12 row_mask:0xf bank_mask:0xf
    v_and_b32_dpp v27, v38, v7 row_newbcast:12 row_mask:0xf bank_mask:0xf
    s_nop 1
    v_mfma_f32_16x16x32_bf16 v[28:31], v[24:27], v[188:191], v[28:31]
    v_add_u32 v35, 512, v35
    s_add_u32 s45, s45, 1
    s_cmp_lt_u32 s45, 4
    s_cbranch_scc1 L_vloop
    v_mov_b32 v33, 0
    ds_write_b32 v33, v50 offset:9280
    s_mov_b32 s45, 0
L_vloop2:
    s_waitcnt vmcnt(7)
    buffer_load_dwordx4 v[140:143], v2, s[40:43], s44 offen offset:3072 nt
    s_add_u32 s44, s44, 16384
    ds_read_b32 v39, v35 offset:64
    v_and_b32_dpp v24, v37, v4 row_newbcast:0 row_mask:0xf bank_mask:0xf
    v_and_b32_dpp v25, v37, v5 row_newbcast:0 row_mask:0xf bank_mask:0xf
    v_and_b32_dpp v26, v37, v6 row_newbcast:0 row_mask:0xf bank_mask:0xf
    v_and_b32_dpp v27, v37, v7 row_newbcast:0 row_mask:0xf bank_mask:0xf
    s_nop 1
    v_mfma_f32_16x16x32_bf16 v[28:31], v[24:27], v[64:67], v[28:31]
    s_waitcnt vmcnt(7)
    buffer_load_dwordx4 v[144:147], v2, s[40:43], s44 offen offset:0 nt
    v_and_b32_dpp v24, v37, v4 row_newbcast:4 row_mask:0xf bank_mask:0xf
    v_and_b32_dpp v25, v37, v5 row_newbcast:4 row_mask:0xf bank_mask:0xf
    v_and_b32_dpp v26, v37, v6 row_newbcast:4 row_mask:0xf bank_mask:0xf
    v_and_b32_dpp v27, v37, v7 row_newbcast:4 row_mask:0xf bank_mask:0xf
    s_nop 1
    v_mfma_f32_16x16x32_bf16 v[28:31], v[24:27], v[68:71], v[28:31]
    s_waitcnt vmcnt(7)
    buffer_load_dwordx4 v[148:151], v2, s[40:43], s44 offen offset:1024 nt
    v_and_b32_dpp v24, v37, v4 row_newbcast:8 row_mask:0xf bank_mask:0xf
    v_and_b32_dpp v25, v37, v5 row_newbcast:8 row_mask:0xf bank_mask:0xf
    v_and_b32_dpp v26, v37, v6 row_newbcast:8 row_mask:0xf bank_mask:0xf
    v_and_b32_dpp v27, v37, v7 row_newbcast:8 row_mask:0xf bank_mask:0xf
    s_nop 1
    v_mfma_f32_16x16x32_bf16 v[28:31], v[24:27], v[72:75], v[28:31]
    s_waitcnt lgkmcnt(0)
    v_sub_f32 v39, v39, v41
    v_mul_f32 v39, s55, v39
    v_exp_f32 v39, v39
    s_nop 0
    v_mul_f32 v39, v39, v47
    v_cvt_pk_bf16_f32 v38, v39, v39
    s_waitcnt vmcnt(7)
    buffer_load_dwordx4 v[152:155], v2, s[40:43], s44 offen offset:2048 nt
    v_and_b32_dpp v24, v37, v4 row_newbcast:12 row_mask:0xf bank_mask:0xf
    v_and_b32_dpp v25, v37, v5 row_newbcast:12 row_mask:0xf bank_mask:0xf
    v_and_b32_dpp v26, v37, v6 row_newbcast:12 row_mask:0xf bank_mask:0xf
    v_and_b32_dpp v27, v37, v7 row_newbcast:12 row_mask:0xf bank_mask:0xf
    s_nop 1
    v_mfma_f32_16x16x32_bf16 v[28:31], v[24:27], v[76:79], v[28:31]
    s_waitcnt vmcnt(7)
    buffer_load_dwordx4 v[156:159], v2, s[40:43], s44 offen offset:3072 nt
    s_add_u32 s44, s44, 16384
    ds_read_b32 v39, v35 offset:128
    v_and_b32_dpp v24, v38, v4 row_newbcast:0 row_mask:0xf bank_mask:0xf
    v_and_b32_dpp v25, v38, v5 row_newbcast:0 row_mask:0xf bank_mask:0xf
    v_and_b32_dpp v26, v38, v6 row_newbcast:0 row_mask:0xf bank_mask:0xf
    v_and_b32_dpp v27, v38, v7 row_newbcast:0 row_mask:0xf bank_mask:0xf
    s_nop 1
    v_mfma_f32_16x16x32_bf16 v[28:31], v[24:27], v[80:83], v[28:31]
    s_waitcnt vmcnt(7)
    buffer_load_dwordx4 v[160:163], v2, s[40:43], s44 offen offset:0 nt
    v_and_b32_dpp v24, v38, v4 row_newbcast:4 row_mask:0xf bank_mask:0xf
    v_and_b32_dpp v25, v38, v5 row_newbcast:4 row_mask:0xf bank_mask:0xf
    v_and_b32_dpp v26, v38, v6 row_newbcast:4 row_mask:0xf bank_mask:0xf
    v_and_b32_dpp v27, v38, v7 row_newbcast:4 row_mask:0xf bank_mask:0xf
    s_nop 1
    v_mfma_f32_16x16x32_bf16 v[28:31], v[24:27], v[84:87], v[28:31]
    s_waitcnt vmcnt(7)
    buffer_load_dwordx4 v[164:167], v2, s[40:43], s44 offen offset:1024 nt
    v_and_b32_dpp v24, v38, v4 row_newbcast:8 row_mask:0xf bank_mask:0xf
    v_and_b32_dpp v25, v38, v5 row_newbcast:8 row_mask:0xf bank_mask:0xf
    v_and_b32_dpp v26, v38, v6 row_newbcast:8 row_mask:0xf bank_mask:0xf
    v_and_b32_dpp v27, v38, v7 row_newbcast:8 row_mask:0xf bank_mask:0xf
    s_nop 1
    v_mfma_f32_16x16x32_bf16 v[28:31], v[24:27], v[88:91], v[28:31]
    s_waitcnt lgkmcnt(0)
    v_sub_f32 v39, v39, v41
    v_mul_f32 v39, s55, v39
    v_exp_f32 v39, v39
    s_nop 0
    v_mul_f32 v39, v39, v47
    v_cvt_pk_bf16_f32 v37, v39, v39
    s_waitcnt vmcnt(7)
    buffer_load_dwordx4 v[168:171], v2, s[40:43], s44 offen offset:2048 nt
    v_and_b32_dpp v24, v38, v4 row_newbcast:12 row_mask:0xf bank_mask:0xf
    v_and_b32_dpp v25, v38, v5 row_newbcast:12 row_mask:0xf bank_mask:0xf
    v_and_b32_dpp v26, v38, v6 row_newbcast:12 row_mask:0xf bank_mask:0xf
    v_and_b32_dpp v27, v38, v7 row_newbcast:12 row_mask:0xf bank_mask:0xf
    s_nop 1
    v_mfma_f32_16x16x32_bf16 v[28:31], v[24:27], v[92:95], v[28:31]
    s_waitcnt vmcnt(7)
    buffer_load_dwordx4 v[172:175], v2, s[40:43], s44 offen offset:3072 nt
    s_add_u32 s44, s44, 16384
    ds_read_b32 v39, v35 offset:192
    v_and_b32_dpp v24, v37, v4 row_newbcast:0 row_mask:0xf bank_mask:0xf
    v_and_b32_dpp v25, v37, v5 row_newbcast:0 row_mask:0xf bank_mask:0xf
    v_and_b32_dpp v26, v37, v6 row_newbcast:0 row_mask:0xf bank_mask:0xf
    v_and_b32_dpp v27, v37, v7 row_newbcast:0 row_mask:0xf bank_mask:0xf
    s_nop 1
    v_mfma_f32_16x16x32_bf16 v[28:31], v[24:27], v[96:99], v[28:31]
    s_waitcnt vmcnt(7)
    buffer_load_dwordx4 v[176:179], v2, s[40:43], s44 offen offset:0 nt
    v_and_b32_dpp v24, v37, v4 row_newbcast:4 row_mask:0xf bank_mask:0xf
    v_and_b32_dpp v25, v37, v5 row_newbcast:4 row_mask:0xf bank_mask:0xf
    v_and_b32_dpp v26, v37, v6 row_newbcast:4 row_mask:0xf bank_mask:0xf
    v_and_b32_dpp v27, v37, v7 row_newbcast:4 row_mask:0xf bank_mask:0xf
    s_nop 1
    v_mfma_f32_16x16x32_bf16 v[28:31], v[24:27], v[100:103], v[28:31]
    s_waitcnt vmcnt(7)
    buffer_load_dwordx4 v[180:183], v2, s[40:43], s44 offen offset:1024 nt
    v_and_b32_dpp v24, v37, v4 row_newbcast:8 row_mask:0xf bank_mask:0xf
    v_and_b32_dpp v25, v37, v5 row_newbcast:8 row_mask:0xf bank_mask:0xf
    v_and_b32_dpp v26, v37, v6 row_newbcast:8 row_mask:0xf bank_mask:0xf
    v_and_b32_dpp v27, v37, v7 row_newbcast:8 row_mask:0xf bank_mask:0xf
    s_nop 1
    v_mfma_f32_16x16x32_bf16 v[28:31], v[24:27], v[104:107], v[28:31]
    s_waitcnt lgkmcnt(0)
    v_sub_f32 v39, v39, v41
    v_mul_f32 v39, s55, v39
    v_exp_f32 v39, v39
    s_nop 0
    v_mul_f32 v39, v39, v47
    v_cvt_pk_bf16_f32 v38, v39, v39
    s_waitcnt vmcnt(7)
    buffer_load_dwordx4 v[184:187], v2, s[40:43], s44 offen offset:2048 nt
    v_and_b32_dpp v24, v37, v4 row_newbcast:12 row_mask:0xf bank_mask:0xf
    v_and_b32_dpp v25, v37, v5 row_newbcast:12 row_mask:0xf bank_mask:0xf
    v_and_b32_dpp v26, v37, v6 row_newbcast:12 row_mask:0xf bank_mask:0xf
    v_and_b32_dpp v27, v37, v7 row_newbcast:12 row_mask:0xf bank_mask:0xf
    s_nop 1
    v_mfma_f32_16x16x32_bf16 v[28:31], v[24:27], v[108:111], v[28:31]
    s_waitcnt vmcnt(7)
    buffer_load_dwordx4 v[188:191], v2, s[40:43], s44 offen offset:3072 nt
    s_add_u32 s44, s44, 16384
    ds_read_b32 v39, v35 offset:256
    v_and_b32_dpp v24, v38, v4 row_newbcast:0 row_mask:0xf bank_mask:0xf
    v_and_b32_dpp v25, v38, v5 row_newbcast:0 row_mask:0xf bank_mask:0xf
    v_and_b32_dpp v26, v38, v6 row_newbcast:0 row_mask:0xf bank_mask:0xf
    v_and_b32_dpp v27, v38, v7 row_newbcast:0 row_mask:0xf bank_mask:0xf
    s_nop 1
    v_mfma_f32_16x16x32_bf16 v[28:31], v[24:27], v[112:115], v[28:31]
    s_waitcnt vmcnt(7)
    buffer_load_dwordx4 v[64:67], v2, s[40:43], s44 offen offset:0 nt
    v_and_b32_dpp v24, v38, v4 row_newbcast:4 row_mask:0xf bank_mask:0xf
    v_and_b32_dpp v25, v38, v5 row_newbcast:4 row_mask:0xf bank_mask:0xf
    v_and_b32_dpp v26, v38, v6 row_newbcast:4 row_mask:0xf bank_mask:0xf
    v_and_b32_dpp v27, v38, v7 row_newbcast:4 row_mask:0xf bank_mask:0xf
    s_nop 1
    v_mfma_f32_16x16x32_bf16 v[28:31], v[24:27], v[116:119], v[28:31]
    s_waitcnt vmcnt(7)
    buffer_load_dwordx4 v[68:71], v2, s[40:43], s44 offen offset:1024 nt
    v_and_b32_dpp v24, v38, v4 row_newbcast:8 row_mask:0xf bank_mask:0xf
    v_and_b32_dpp v25, v38, v5 row_newbcast:8 row_mask:0xf bank_mask:0xf
    v_and_b32_dpp v26, v38, v6 row_newbcast:8 row_mask:0xf bank_mask:0xf
    v_and_b32_dpp v27, v38, v7 row_newbcast:8 row_mask:0xf bank_mask:0xf
    s_nop 1
    v_mfma_f32_16x16x32_bf16 v[28:31], v[24:27], v[120:123], v[28:31]
    s_waitcnt lgkmcnt(0)
    v_sub_f32 v39, v39, v41
    v_mul_f32 v39, s55, v39
    v_exp_f32 v39, v39
    s_nop 0
    v_mul_f32 v39, v39, v47
    v_cvt_pk_bf16_f32 v37, v39, v39
    s_waitcnt vmcnt(7)
    buffer_load_dwordx4 v[72:75], v2, s[40:43], s44 offen offset:2048 nt
    v_and_b32_dpp v24, v38, v4 row_newbcast:12 row_mask:0xf bank_mask:0xf
    v_and_b32_dpp v25, v38, v5 row_newbcast:12 row_mask:0xf bank_mask:0xf
    v_and_b32_dpp v26, v38, v6 row_newbcast:12 row_mask:0xf bank_mask:0xf
    v_and_b32_dpp v27, v38, v7 row_newbcast:12 row_mask:0xf bank_mask:0xf
    s_nop 1
    v_mfma_f32_16x16x32_bf16 v[28:31], v[24:27], v[124:127], v[28:31]
    s_waitcnt vmcnt(7)
    buffer_load_dwordx4 v[76:79], v2, s[40:43], s44 offen offset:3072 nt
    s_add_u32 s44, s44, 16384
    ds_read_b32 v39, v35 offset:320
    v_and_b32_dpp v24, v37, v4 row_newbcast:0 row_mask:0xf bank_mask:0xf
    v_and_b32_dpp v25, v37, v5 row_newbcast:0 row_mask:0xf bank_mask:0xf
    v_and_b32_dpp v26, v37, v6 row_newbcast:0 row_mask:0xf bank_mask:0xf
    v_and_b32_dpp v27, v37, v7 row_newbcast:0 row_mask:0xf bank_mask:0xf
    s_nop 1
    v_mfma_f32_16x16x32_bf16 v[28:31], v[24:27], v[128:131], v[28:31]
    s_waitcnt vmcnt(7)
    buffer_load_dwordx4 v[80:83], v2, s[40:43], s44 offen offset:0 nt
    v_and_b32_dpp v24, v37, v4 row_newbcast:4 row_mask:0xf bank_mask:0xf
    v_and_b32_dpp v25, v37, v5 row_newbcast:4 row_mask:0xf bank_mask:0xf
    v_and_b32_dpp v26, v37, v6 row_newbcast:4 row_mask:0xf bank_mask:0xf
    v_and_b32_dpp v27, v37, v7 row_newbcast:4 row_mask:0xf bank_mask:0xf
    s_nop 1
    v_mfma_f32_16x16x32_bf16 v[28:31], v[24:27], v[132:135], v[28:31]
    s_waitcnt vmcnt(7)
    buffer_load_dwordx4 v[84:87], v2, s[40:43], s44 offen offset:1024 nt
    v_and_b32_dpp v24, v37, v4 row_newbcast:8 row_mask:0xf bank_mask:0xf
    v_and_b32_dpp v25, v37, v5 row_newbcast:8 row_mask:0xf bank_mask:0xf
    v_and_b32_dpp v26, v37, v6 row_newbcast:8 row_mask:0xf bank_mask:0xf
    v_and_b32_dpp v27, v37, v7 row_newbcast:8 row_mask:0xf bank_mask:0xf
    s_nop 1
    v_mfma_f32_16x16x32_bf16 v[28:31], v[24:27], v[136:139], v[28:31]
    s_waitcnt lgkmcnt(0)
    v_sub_f32 v39, v39, v41
    v_mul_f32 v39, s55, v39
    v_exp_f32 v39, v39
    s_nop 0
    v_mul_f32 v39, v39, v47
    v_cvt_pk_bf16_f32 v38, v39, v39
    s_waitcnt vmcnt(7)
    buffer_load_dwordx4 v[88:91], v2, s[40:43], s44 offen offset:2048 nt
    v_and_b32_dpp v24, v37, v4 row_newbcast:12 row_mask:0xf bank_mask:0xf
    v_and_b32_dpp v25, v37, v5 row_newbcast:12 row_mask:0xf bank_mask:0xf
    v_and_b32_dpp v26, v37, v6 row_newbcast:12 row_mask:0xf bank_mask:0xf
    v_and_b32_dpp v27, v37, v7 row_newbcast:12 row_mask:0xf bank_mask:0xf
    s_nop 1
    v_mfma_f32_16x16x32_bf16 v[28:31], v[24:27], v[140:143], v[28:31]
    s_waitcnt vmcnt(7)
    buffer_load_dwordx4 v[92:95], v2, s[40:43], s44 offen offset:3072 nt
    s_add_u32 s44, s44, 16384
    ds_read_b32 v39, v35 offset:384
    v_and_b32_dpp v24, v38, v4 row_newbcast:0 row_mask:0xf bank_mask:0xf
    v_and_b32_dpp v25, v38, v5 row_newbcast:0 row_mask:0xf bank_mask:0xf
    v_and_b32_dpp v26, v38, v6 row_newbcast:0 row_mask:0xf bank_mask:0xf
    v_and_b32_dpp v27, v38, v7 row_newbcast:0 row_mask:0xf bank_mask:0xf
    s_nop 1
    v_mfma_f32_16x16x32_bf16 v[28:31], v[24:27], v[144:147], v[28:31]
    s_waitcnt vmcnt(7)
    buffer_load_dwordx4 v[96:99], v2, s[40:43], s44 offen offset:0 nt
    v_and_b32_dpp v24, v38, v4 row_newbcast:4 row_mask:0xf bank_mask:0xf
    v_and_b32_dpp v25, v38, v5 row_newbcast:4 row_mask:0xf bank_mask:0xf
    v_and_b32_dpp v26, v38, v6 row_newbcast:4 row_mask:0xf bank_mask:0xf
    v_and_b32_dpp v27, v38, v7 row_newbcast:4 row_mask:0xf bank_mask:0xf
    s_nop 1
    v_mfma_f32_16x16x32_bf16 v[28:31], v[24:27], v[148:151], v[28:31]
    s_waitcnt vmcnt(7)
    buffer_load_dwordx4 v[100:103], v2, s[40:43], s44 offen offset:1024 nt
    v_and_b32_dpp v24, v38, v4 row_newbcast:8 row_mask:0xf bank_mask:0xf
    v_and_b32_dpp v25, v38, v5 row_newbcast:8 row_mask:0xf bank_mask:0xf
    v_and_b32_dpp v26, v38, v6 row_newbcast:8 row_mask:0xf bank_mask:0xf
    v_and_b32_dpp v27, v38, v7 row_newbcast:8 row_mask:0xf bank_mask:0xf
    s_nop 1
    v_mfma_f32_16x16x32_bf16 v[28:31], v[24:27], v[152:155], v[28:31]
    s_waitcnt lgkmcnt(0)
    v_sub_f32 v39, v39, v41
    v_mul_f32 v39, s55, v39
    v_exp_f32 v39, v39
    s_nop 0
    v_mul_f32 v39, v39, v47
    v_cvt_pk_bf16_f32 v37, v39, v39
    s_waitcnt vmcnt(7)
    buffer_load_dwordx4 v[104:107], v2, s[40:43], s44 offen offset:2048 nt
    v_and_b32_dpp v24, v38, v4 row_newbcast:12 row_mask:0xf bank_mask:0xf
    v_and_b32_dpp v25, v38, v5 row_newbcast:12 row_mask:0xf bank_mask:0xf
    v_and_b32_dpp v26, v38, v6 row_newbcast:12 row_mask:0xf bank_mask:0xf
    v_and_b32_dpp v27, v38, v7 row_newbcast:12 row_mask:0xf bank_mask:0xf
    s_nop 1
    v_mfma_f32_16x16x32_bf16 v[28:31], v[24:27], v[156:159], v[28:31]
    s_waitcnt vmcnt(7)
    buffer_load_dwordx4 v[108:111], v2, s[40:43], s44 offen offset:3072 nt
    s_add_u32 s44, s44, 16384
    ds_read_b32 v39, v35 offset:448
    v_and_b32_dpp v24, v37, v4 row_newbcast:0 row_mask:0xf bank_mask:0xf
    v_and_b32_dpp v25, v37, v5 row_newbcast:0 row_mask:0xf bank_mask:0xf
    v_and_b32_dpp v26, v37, v6 row_newbcast:0 row_mask:0xf bank_mask:0xf
    v_and_b32_dpp v27, v37, v7 row_newbcast:0 row_mask:0xf bank_mask:0xf
    s_nop 1
    v_mfma_f32_16x16x32_bf16 v[28:31], v[24:27], v[160:163], v[28:31]
    s_waitcnt vmcnt(7)
    buffer_load_dwordx4 v[112:115], v2, s[40:43], s44 offen offset:0 nt
    v_and_b32_dpp v24, v37, v4 row_newbcast:4 row_mask:0xf bank_mask:0xf
    v_and_b32_dpp v25, v37, v5 row_newbcast:4 row_mask:0xf bank_mask:0xf
    v_and_b32_dpp v26, v37, v6 row_newbcast:4 row_mask:0xf bank_mask:0xf
    v_and_b32_dpp v27, v37, v7 row_newbcast:4 row_mask:0xf bank_mask:0xf
    s_nop 1
    v_mfma_f32_16x16x32_bf16 v[28:31], v[24:27], v[164:167], v[28:31]
    s_waitcnt vmcnt(7)
    buffer_load_dwordx4 v[116:119], v2, s[40:43], s44 offen offset:1024 nt
    v_and_b32_dpp v24, v37, v4 row_newbcast:8 row_mask:0xf bank_mask:0xf
    v_and_b32_dpp v25, v37, v5 row_newbcast:8 row_mask:0xf bank_mask:0xf
    v_and_b32_dpp v26, v37, v6 row_newbcast:8 row_mask:0xf bank_mask:0xf
    v_and_b32_dpp v27, v37, v7 row_newbcast:8 row_mask:0xf bank_mask:0xf
    s_nop 1
    v_mfma_f32_16x16x32_bf16 v[28:31], v[24:27], v[168:171], v[28:31]
    s_waitcnt lgkmcnt(0)
    v_sub_f32 v39, v39, v41
    v_mul_f32 v39, s55, v39
    v_exp_f32 v39, v39
    s_nop 0
    v_mul_f32 v39, v39, v47
    v_cvt_pk_bf16_f32 v38, v39, v39
    s_waitcnt vmcnt(7)
    buffer_load_dwordx4 v[120:123], v2, s[40:43], s44 offen offset:2048 nt
    v_and_b32_dpp v24, v37, v4 row_newbcast:12 row_mask:0xf bank_mask:0xf
    v_and_b32_dpp v25, v37, v5 row_newbcast:12 row_mask:0xf bank_mask:0xf
    v_and_b32_dpp v26, v37, v6 row_newbcast:12 row_mask:0xf bank_mask:0xf
    v_and_b32_dpp v27, v37, v7 row_newbcast:12 row_mask:0xf bank_mask:0xf
    s_nop 1
    v_mfma_f32_16x16x32_bf16 v[28:31], v[24:27], v[172:175], v[28:31]
    s_waitcnt vmcnt(7)
    buffer_load_dwordx4 v[124:127], v2, s[40:43], s44 offen offset:3072 nt
    s_add_u32 s44, s44, 16384
    ds_read_b32 v39, v35 offset:512
    v_and_b32_dpp v24, v38, v4 row_newbcast:0 row_mask:0xf bank_mask:0xf
    v_and_b32_dpp v25, v38, v5 row_newbcast:0 row_mask:0xf bank_mask:0xf
    v_and_b32_dpp v26, v38, v6 row_newbcast:0 row_mask:0xf bank_mask:0xf
    v_and_b32_dpp v27, v38, v7 row_newbcast:0 row_mask:0xf bank_mask:0xf
    s_nop 1
    v_mfma_f32_16x16x32_bf16 v[28:31], v[24:27], v[176:179], v[28:31]
    s_waitcnt vmcnt(7)
    buffer_load_dwordx4 v[128:131], v2, s[40:43], s44 offen offset:0 nt
    v_and_b32_dpp v24, v38, v4 row_newbcast:4 row_mask:0xf bank_mask:0xf
    v_and_b32_dpp v25, v38, v5 row_newbcast:4 row_mask:0xf bank_mask:0xf
    v_and_b32_dpp v26, v38, v6 row_newbcast:4 row_mask:0xf bank_mask:0xf
    v_and_b32_dpp v27, v38, v7 row_newbcast:4 row_mask:0xf bank_mask:0xf
    s_nop 1
    v_mfma_f32_16x16x32_bf16 v[28:31], v[24:27], v[180:183], v[28:31]
    s_waitcnt vmcnt(7)
    buffer_load_dwordx4 v[132:135], v2, s[40:43], s44 offen offset:1024 nt
    v_and_b32_dpp v24, v38, v4 row_newbcast:8 row_mask:0xf bank_mask:0xf
    v_and_b32_dpp v25, v38, v5 row_newbcast:8 row_mask:0xf bank_mask:0xf
    v_and_b32_dpp v26, v38, v6 row_newbcast:8 row_mask:0xf bank_mask:0xf
    v_and_b32_dpp v27, v38, v7 row_newbcast:8 row_mask:0xf bank_mask:0xf
    s_nop 1
    v_mfma_f32_16x16x32_bf16 v[28:31], v[24:27], v[184:187], v[28:31]
    s_waitcnt lgkmcnt(0)
    v_sub_f32 v39, v39, v41
    v_mul_f32 v39, s55, v39
    v_exp_f32 v39, v39
    s_nop 0
    v_mul_f32 v39, v39, v47
    v_cvt_pk_bf16_f32 v37, v39, v39
    s_waitcnt vmcnt(7)
    buffer_load_dwordx4 v[136:139], v2, s[40:43], s44 offen offset:2048 nt
    v_and_b32_dpp v24, v38, v4 row_newbcast:12 row_mask:0xf bank_mask:0xf
    v_and_b32_dpp v25, v38, v5 row_newbcast:12 row_mask:0xf bank_mask:0xf
    v_and_b32_dpp v26, v38, v6 row_newbcast:12 row_mask:0xf bank_mask:0xf
    v_and_b32_dpp v27, v38, v7 row_newbcast:12 row_mask:0xf bank_mask:0xf
    s_nop 1
    v_mfma_f32_16x16x32_bf16 v[28:31], v[24:27], v[188:191], v[28:31]
    v_add_u32 v35, 512, v35
    s_add_u32 s45, s45, 1
    s_cmp_lt_u32 s45, 3
    s_cbranch_scc1 L_vloop2
    s_mul_i32 s7, s12, 81920
    s_lshl_b32 s8, s67, 8
    s_add_u32 s7, s7, s8
    v_lshrrev_b32 v8, 4, v1
    v_mul_u32_u24 v8, 2560, v8
    v_and_b32 v9, 15, v1
    v_lshl_add_u32 v8, v9, 4, v8
    v_add_u32 v52, s7, v8
    v_add_u32 v53, 10240, v52
    v_add_u32 v54, 10240, v53
    v_add_u32 v55, 10240, v54
    v_add_u32 v56, 10240, v55
    v_add_u32 v57, 10240, v56
    v_add_u32 v58, 10240, v57
    v_add_u32 v59, 10240, v58
    v_add_u32 v44, 655360, v44
    s_lshl_b32 s7, s3, 6
    v_add_u32 v18, s7, v1
    v_lshrrev_b32 v8, 1, v18
    v_and_b32 v9, 1, v18
    s_lshl_b32 s8, s67, 5
    s_mov_b32 s71, 0x20000
    s_mov_b32 s75, 0x20000
    s_sub_u32 s70, 2211840, s8
    s_mov_b32 s74, s70
    s_mov_b32 s76, 0
    s_cmp_eq_u32 s66, 0
    s_cbranch_scc0 L_sgB_2
    s_add_u32 s68, s28, s8
    s_addc_u32 s69, s29, 0
    s_add_u32 s72, s30, s8
    s_addc_u32 s73, s31, 0
    s_mov_b32 s7, 3456
    v_mul_lo_u32 v10, v8, s7
    v_lshl_add_u32 v10, v9, 4, v10
    v_lshlrev_b32 v11, 5, v18
    s_branch L_sgD_3
L_sgB_2:
    s_add_u32 s68, s32, s8
    s_addc_u32 s69, s33, 0
    s_mov_b32 s72, s68
    s_mov_b32 s73, s69
    v_mul_u32_u24 v10, 1280, v8
    v_lshl_add_u32 v10, v9, 4, v10
    v_lshlrev_b32 v11, 4, v18
L_sgD_3:
    v_add_u32 v11, 46336, v11
    s_waitcnt vmcnt(7)
    buffer_load_dwordx4 v[140:143], v2, s[40:43], s44 offen offset:3072 nt
    s_add_u32 s44, s44, 16384
    ds_read_b32 v39, v35 offset:64
    v_and_b32_dpp v24, v37, v4 row_newbcast:0 row_mask:0xf bank_mask:0xf
    v_and_b32_dpp v25, v37, v5 row_newbcast:0 row_mask:0xf bank_mask:0xf
    v_and_b32_dpp v26, v37, v6 row_newbcast:0 row_mask:0xf bank_mask:0xf
    v_and_b32_dpp v27, v37, v7 row_newbcast:0 row_mask:0xf bank_mask:0xf
    s_nop 1
    v_mfma_f32_16x16x32_bf16 v[28:31], v[24:27], v[64:67], v[28:31]
    s_waitcnt vmcnt(7)
    buffer_load_dwordx4 v[144:147], v2, s[40:43], s44 offen offset:0 nt
    v_and_b32_dpp v24, v37, v4 row_newbcast:4 row_mask:0xf bank_mask:0xf
    v_and_b32_dpp v25, v37, v5 row_newbcast:4 row_mask:0xf bank_mask:0xf
    v_and_b32_dpp v26, v37, v6 row_newbcast:4 row_mask:0xf bank_mask:0xf
    v_and_b32_dpp v27, v37, v7 row_newbcast:4 row_mask:0xf bank_mask:0xf
    s_nop 1
    v_mfma_f32_16x16x32_bf16 v[28:31], v[24:27], v[68:71], v[28:31]
    s_waitcnt vmcnt(7)
    buffer_load_dwordx4 v[148:151], v2, s[40:43], s44 offen offset:1024 nt
    v_and_b32_dpp v24, v37, v4 row_newbcast:8 row_mask:0xf bank_mask:0xf
    v_and_b32_dpp v25, v37, v5 row_newbcast:8 row_mask:0xf bank_mask:0xf
    v_and_b32_dpp v26, v37, v6 row_newbcast:8 row_mask:0xf bank_mask:0xf
    v_and_b32_dpp v27, v37, v7 row_newbcast:8 row_mask:0xf bank_mask:0xf
    s_nop 1
    v_mfma_f32_16x16x32_bf16 v[28:31], v[24:27], v[72:75], v[28:31]
    s_waitcnt lgkmcnt(0)
    v_sub_f32 v39, v39, v41
    v_mul_f32 v39, s55, v39
    v_exp_f32 v39, v39
    s_nop 0
    v_mul_f32 v39, v39, v47
    v_cvt_pk_bf16_f32 v38, v39, v39
    s_waitcnt vmcnt(7)
    buffer_load_dwordx4 v[152:155], v2, s[40:43], s44 offen offset:2048 nt
    v_and_b32_dpp v24, v37, v4 row_newbcast:12 row_mask:0xf bank_mask:0xf
    v_and_b32_dpp v25, v37, v5 row_newbcast:12 row_mask:0xf bank_mask:0xf
    v_and_b32_dpp v26, v37, v6 row_newbcast:12 row_mask:0xf bank_mask:0xf
    v_and_b32_dpp v27, v37, v7 row_newbcast:12 row_mask:0xf bank_mask:0xf
    s_nop 1
    v_mfma_f32_16x16x32_bf16 v[28:31], v[24:27], v[76:79], v[28:31]
    s_waitcnt vmcnt(7)
    buffer_load_dwordx4 v[156:159], v2, s[40:43], s44 offen offset:3072 nt
    s_add_u32 s44, s44, 16384
    ds_read_b32 v39, v35 offset:128
    v_and_b32_dpp v24, v38, v4 row_newbcast:0 row_mask:0xf bank_mask:0xf
    v_and_b32_dpp v25, v38, v5 row_newbcast:0 row_mask:0xf bank_mask:0xf
    v_and_b32_dpp v26, v38, v6 row_newbcast:0 row_mask:0xf bank_mask:0xf
    v_and_b32_dpp v27, v38, v7 row_newbcast:0 row_mask:0xf bank_mask:0xf
    s_nop 1
    v_mfma_f32_16x16x32_bf16 v[28:31], v[24:27], v[80:83], v[28:31]
    s_waitcnt vmcnt(7)
    buffer_load_dwordx4 v[160:163], v2, s[40:43], s44 offen offset:0 nt
    v_and_b32_dpp v24, v38, v4 row_newbcast:4 row_mask:0xf bank_mask:0xf
    v_and_b32_dpp v25, v38, v5 row_newbcast:4 row_mask:0xf bank_mask:0xf
    v_and_b32_dpp v26, v38, v6 row_newbcast:4 row_mask:0xf bank_mask:0xf
    v_and_b32_dpp v27, v38, v7 row_newbcast:4 row_mask:0xf bank_mask:0xf
    s_nop 1
    v_mfma_f32_16x16x32_bf16 v[28:31], v[24:27], v[84:87], v[28:31]
    s_waitcnt vmcnt(7)
    buffer_load_dwordx4 v[164:167], v2, s[40:43], s44 offen offset:1024 nt
    v_and_b32_dpp v24, v38, v4 row_newbcast:8 row_mask:0xf bank_mask:0xf
    v_and_b32_dpp v25, v38, v5 row_newbcast:8 row_mask:0xf bank_mask:0xf
    v_and_b32_dpp v26, v38, v6 row_newbcast:8 row_mask:0xf bank_mask:0xf
    v_and_b32_dpp v27, v38, v7 row_newbcast:8 row_mask:0xf bank_mask:0xf
    s_nop 1
    v_mfma_f32_16x16x32_bf16 v[28:31], v[24:27], v[88:91], v[28:31]
    s_waitcnt lgkmcnt(0)
    v_sub_f32 v39, v39, v41
    v_mul_f32 v39, s55, v39
    v_exp_f32 v39, v39
    s_nop 0
    v_mul_f32 v39, v39, v47
    v_cvt_pk_bf16_f32 v37, v39, v39
    s_waitcnt vmcnt(7)
    buffer_load_dwordx4 v[168:171], v2, s[40:43], s44 offen offset:2048 nt
    v_and_b32_dpp v24, v38, v4 row_newbcast:12 row_mask:0xf bank_mask:0xf
    v_and_b32_dpp v25, v38, v5 row_newbcast:12 row_mask:0xf bank_mask:0xf
    v_and_b32_dpp v26, v38, v6 row_newbcast:12 row_mask:0xf bank_mask:0xf
    v_and_b32_dpp v27, v38, v7 row_newbcast:12 row_mask:0xf bank_mask:0xf
    s_nop 1
    v_mfma_f32_16x16x32_bf16 v[28:31], v[24:27], v[92:95], v[28:31]
    s_waitcnt vmcnt(7)
    buffer_load_dwordx4 v[172:175], v2, s[40:43], s44 offen offset:3072 nt
    s_add_u32 s44, s44, 16384
    ds_read_b32 v39, v35 offset:192
    v_and_b32_dpp v24, v37, v4 row_newbcast:0 row_mask:0xf bank_mask:0xf
    v_and_b32_dpp v25, v37, v5 row_newbcast:0 row_mask:0xf bank_mask:0xf
    v_and_b32_dpp v26, v37, v6 row_newbcast:0 row_mask:0xf bank_mask:0xf
    v_and_b32_dpp v27, v37, v7 row_newbcast:0 row_mask:0xf bank_mask:0xf
    s_nop 1
    v_mfma_f32_16x16x32_bf16 v[28:31], v[24:27], v[96:99], v[28:31]
    s_waitcnt vmcnt(7)
    buffer_load_dwordx4 v[176:179], v2, s[40:43], s44 offen offset:0 nt
    v_and_b32_dpp v24, v37, v4 row_newbcast:4 row_mask:0xf bank_mask:0xf
    v_and_b32_dpp v25, v37, v5 row_newbcast:4 row_mask:0xf bank_mask:0xf
    v_and_b32_dpp v26, v37, v6 row_newbcast:4 row_mask:0xf bank_mask:0xf
    v_and_b32_dpp v27, v37, v7 row_newbcast:4 row_mask:0xf bank_mask:0xf
    s_nop 1
    v_mfma_f32_16x16x32_bf16 v[28:31], v[24:27], v[100:103], v[28:31]
    s_waitcnt vmcnt(7)
    buffer_load_dwordx4 v[180:183], v2, s[40:43], s44 offen offset:1024 nt
    v_and_b32_dpp v24, v37, v4 row_newbcast:8 row_mask:0xf bank_mask:0xf
    v_and_b32_dpp v25, v37, v5 row_newbcast:8 row_mask:0xf bank_mask:0xf
    v_and_b32_dpp v26, v37, v6 row_newbcast:8 row_mask:0xf bank_mask:0xf
    v_and_b32_dpp v27, v37, v7 row_newbcast:8 row_mask:0xf bank_mask:0xf
    s_nop 1
    v_mfma_f32_16x16x32_bf16 v[28:31], v[24:27], v[104:107], v[28:31]
    s_waitcnt lgkmcnt(0)
    v_sub_f32 v39, v39, v41
    v_mul_f32 v39, s55, v39
    v_exp_f32 v39, v39
    s_nop 0
    v_mul_f32 v39, v39, v47
    v_cvt_pk_bf16_f32 v38, v39, v39
    s_waitcnt vmcnt(7)
    buffer_load_dwordx4 v[184:187], v2, s[40:43], s44 offen offset:2048 nt
    v_and_b32_dpp v24, v37, v4 row_newbcast:12 row_mask:0xf bank_mask:0xf
    v_and_b32_dpp v25, v37, v5 row_newbcast:12 row_mask:0xf bank_mask:0xf
    v_and_b32_dpp v26, v37, v6 row_newbcast:12 row_mask:0xf bank_mask:0xf
    v_and_b32_dpp v27, v37, v7 row_newbcast:12 row_mask:0xf bank_mask:0xf
    s_nop 1
    v_mfma_f32_16x16x32_bf16 v[28:31], v[24:27], v[108:111], v[28:31]
    s_waitcnt vmcnt(7)
    buffer_load_dwordx4 v[188:191], v2, s[40:43], s44 offen offset:3072 nt
    s_add_u32 s44, s44, 16384
    ds_read_b32 v39, v35 offset:256
    v_and_b32_dpp v24, v38, v4 row_newbcast:0 row_mask:0xf bank_mask:0xf
    v_and_b32_dpp v25, v38, v5 row_newbcast:0 row_mask:0xf bank_mask:0xf
    v_and_b32_dpp v26, v38, v6 row_newbcast:0 row_mask:0xf bank_mask:0xf
    v_and_b32_dpp v27, v38, v7 row_newbcast:0 row_mask:0xf bank_mask:0xf
    s_nop 1
    v_mfma_f32_16x16x32_bf16 v[28:31], v[24:27], v[112:115], v[28:31]
    v_and_b32_dpp v24, v38, v4 row_newbcast:4 row_mask:0xf bank_mask:0xf
    v_and_b32_dpp v25, v38, v5 row_newbcast:4 row_mask:0xf bank_mask:0xf
    v_and_b32_dpp v26, v38, v6 row_newbcast:4 row_mask:0xf bank_mask:0xf
    v_and_b32_dpp v27, v38, v7 row_newbcast:4 row_mask:0xf bank_mask:0xf
    s_nop 1
    v_mfma_f32_16x16x32_bf16 v[28:31], v[24:27], v[116:119], v[28:31]
    v_and_b32_dpp v24, v38, v4 row_newbcast:8 row_mask:0xf bank_mask:0xf
    v_and_b32_dpp v25, v38, v5 row_newbcast:8 row_mask:0xf bank_mask:0xf
    v_and_b32_dpp v26, v38, v6 row_newbcast:8 row_mask:0xf bank_mask:0xf
    v_and_b32_dpp v27, v38, v7 row_newbcast:8 row_mask:0xf bank_mask:0xf
    s_nop 1
    v_mfma_f32_16x16x32_bf16 v[28:31], v[24:27], v[120:123], v[28:31]
    s_waitcnt lgkmcnt(0)
    v_sub_f32 v39, v39, v41
    v_mul_f32 v39, s55, v39
    v_exp_f32 v39, v39
    s_nop 0
    v_mul_f32 v39, v39, v47
    v_cvt_pk_bf16_f32 v37, v39, v39
    v_and_b32_dpp v24, v38, v4 row_newbcast:12 row_mask:0xf bank_mask:0xf
    v_and_b32_dpp v25, v38, v5 row_newbcast:12 row_mask:0xf bank_mask:0xf
    v_and_b32_dpp v26, v38, v6 row_newbcast:12 row_mask:0xf bank_mask:0xf
    v_and_b32_dpp v27, v38, v7 row_newbcast:12 row_mask:0xf bank_mask:0xf
    s_nop 1
    v_mfma_f32_16x16x32_bf16 v[28:31], v[24:27], v[124:127], v[28:31]
    ds_read_b32 v39, v35 offset:320
    v_and_b32_dpp v24, v37, v4 row_newbcast:0 row_mask:0xf bank_mask:0xf
    v_and_b32_dpp v25, v37, v5 row_newbcast:0 row_mask:0xf bank_mask:0xf
    v_and_b32_dpp v26, v37, v6 row_newbcast:0 row_mask:0xf bank_mask:0xf
    v_and_b32_dpp v27, v37, v7 row_newbcast:0 row_mask:0xf bank_mask:0xf
    s_nop 1
    v_mfma_f32_16x16x32_bf16 v[28:31], v[24:27], v[128:131], v[28:31]
    v_and_b32_dpp v24, v37, v4 row_newbcast:4 row_mask:0xf bank_mask:0xf
    v_and_b32_dpp v25, v37, v5 row_newbcast:4 row_mask:0xf bank_mask:0xf
    v_and_b32_dpp v26, v37, v6 row_newbcast:4 row_mask:0xf bank_mask:0xf
    v_and_b32_dpp v27, v37, v7 row_newbcast:4 row_mask:0xf bank_mask:0xf
    s_nop 1
    v_mfma_f32_16x16x32_bf16 v[28:31], v[24:27], v[132:135], v[28:31]
    v_and_b32_dpp v24, v37, v4 row_newbcast:8 row_mask:0xf bank_mask:0xf
    v_and_b32_dpp v25, v37, v5 row_newbcast:8 row_mask:0xf bank_mask:0xf
    v_and_b32_dpp v26, v37, v6 row_newbcast:8 row_mask:0xf bank_mask:0xf
    v_and_b32_dpp v27, v37, v7 row_newbcast:8 row_mask:0xf bank_mask:0xf
    s_nop 1
    v_mfma_f32_16x16x32_bf16 v[28:31], v[24:27], v[136:139], v[28:31]
    s_waitcnt lgkmcnt(0)
    v_sub_f32 v39, v39, v41
    v_mul_f32 v39, s55, v39
    v_exp_f32 v39, v39
    s_nop 0
    v_mul_f32 v39, v39, v47
    v_cvt_pk_bf16_f32 v38, v39, v39
    v_and_b32_dpp v24, v37, v4 row_newbcast:12 row_mask:0xf bank_mask:0xf
    v_and_b32_dpp v25, v37, v5 row_newbcast:12 row_mask:0xf bank_mask:0xf
    v_and_b32_dpp v26, v37, v6 row_newbcast:12 row_mask:0xf bank_mask:0xf
    v_and_b32_dpp v27, v37, v7 row_newbcast:12 row_mask:0xf bank_mask:0xf
    s_nop 1
    v_mfma_f32_16x16x32_bf16 v[28:31], v[24:27], v[140:143], v[28:31]
    ds_read_b32 v39, v35 offset:384
    v_and_b32_dpp v24, v38, v4 row_newbcast:0 row_mask:0xf bank_mask:0xf
    v_and_b32_dpp v25, v38, v5 row_newbcast:0 row_mask:0xf bank_mask:0xf
    v_and_b32_dpp v26, v38, v6 row_newbcast:0 row_mask:0xf bank_mask:0xf
    v_and_b32_dpp v27, v38, v7 row_newbcast:0 row_mask:0xf bank_mask:0xf
    s_nop 1
    v_mfma_f32_16x16x32_bf16 v[28:31], v[24:27], v[144:147], v[28:31]
    v_and_b32_dpp v24, v38, v4 row_newbcast:4 row_mask:0xf bank_mask:0xf
    v_and_b32_dpp v25, v38, v5 row_newbcast:4 row_mask:0xf bank_mask:0xf
    v_and_b32_dpp v26, v38, v6 row_newbcast:4 row_mask:0xf bank_mask:0xf
    v_and_b32_dpp v27, v38, v7 row_newbcast:4 row_mask:0xf bank_mask:0xf
    s_nop 1
    v_mfma_f32_16x16x32_bf16 v[28:31], v[24:27], v[148:151], v[28:31]
    v_and_b32_dpp v24, v38, v4 row_newbcast:8 row_mask:0xf bank_mask:0xf
    v_and_b32_dpp v25, v38, v5 row_newbcast:8 row_mask:0xf bank_mask:0xf
    v_and_b32_dpp v26, v38, v6 row_newbcast:8 row_mask:0xf bank_mask:0xf
    v_and_b32_dpp v27, v38, v7 row_newbcast:8 row_mask:0xf bank_mask:0xf
    s_nop 1
    v_mfma_f32_16x16x32_bf16 v[28:31], v[24:27], v[152:155], v[28:31]
    s_waitcnt lgkmcnt(0)
    v_sub_f32 v39, v39, v41
    v_mul_f32 v39, s55, v39
    v_exp_f32 v39, v39
    s_nop 0
    v_mul_f32 v39, v39, v47
    v_cvt_pk_bf16_f32 v37, v39, v39
    v_and_b32_dpp v24, v38, v4 row_newbcast:12 row_mask:0xf bank_mask:0xf
    v_and_b32_dpp v25, v38, v5 row_newbcast:12 row_mask:0xf bank_mask:0xf
    v_and_b32_dpp v26, v38, v6 row_newbcast:12 row_mask:0xf bank_mask:0xf
    v_and_b32_dpp v27, v38, v7 row_newbcast:12 row_mask:0xf bank_mask:0xf
    s_nop 1
    v_mfma_f32_16x16x32_bf16 v[28:31], v[24:27], v[156:159], v[28:31]
    ds_read_b32 v39, v35 offset:448
    v_and_b32_dpp v24, v37, v4 row_newbcast:0 row_mask:0xf bank_mask:0xf
    v_and_b32_dpp v25, v37, v5 row_newbcast:0 row_mask:0xf bank_mask:0xf
    v_and_b32_dpp v26, v37, v6 row_newbcast:0 row_mask:0xf bank_mask:0xf
    v_and_b32_dpp v27, v37, v7 row_newbcast:0 row_mask:0xf bank_mask:0xf
    s_nop 0
    s_waitcnt vmcnt(7)
    v_mfma_f32_16x16x32_bf16 v[28:31], v[24:27], v[160:163], v[28:31]
    v_and_b32_dpp v24, v37, v4 row_newbcast:4 row_mask:0xf bank_mask:0xf
    v_and_b32_dpp v25, v37, v5 row_newbcast:4 row_mask:0xf bank_mask:0xf
    v_and_b32_dpp v26, v37, v6 row_newbcast:4 row_mask:0xf bank_mask:0xf
    v_and_b32_dpp v27, v37, v7 row_newbcast:4 row_mask:0xf bank_mask:0xf
    s_nop 0
    s_waitcnt vmcnt(6)
    v_mfma_f32_16x16x32_bf16 v[28:31], v[24:27], v[164:167], v[28:31]
    v_and_b32_dpp v24, v37, v4 row_newbcast:8 row_mask:0xf bank_mask:0xf
    v_and_b32_dpp v25, v37, v5 row_newbcast:8 row_mask:0xf bank_mask:0xf
    v_and_b32_dpp v26, v37, v6 row_newbcast:8 row_mask:0xf bank_mask:0xf
    v_and_b32_dpp v27, v37, v7 row_newbcast:8 row_mask:0xf bank_mask:0xf
    s_nop 0
    s_waitcnt vmcnt(5)
    v_mfma_f32_16x16x32_bf16 v[28:31], v[24:27], v[168:171], v[28:31]
    s_waitcnt lgkmcnt(0)
    v_sub_f32 v39, v39, v41
    v_mul_f32 v39, s55, v39
    v_exp_f32 v39, v39
    s_nop 0
    v_mul_f32 v39, v39, v47
    v_cvt_pk_bf16_f32 v38, v39, v39
    v_and_b32_dpp v24, v37, v4 row_newbcast:12 row_mask:0xf bank_mask:0xf
    v_and_b32_dpp v25, v37, v5 row_newbcast:12 row_mask:0xf bank_mask:0xf
    v_and_b32_dpp v26, v37, v6 row_newbcast:12 row_mask:0xf bank_mask:0xf
    v_and_b32_dpp v27, v37, v7 row_newbcast:12 row_mask:0xf bank_mask:0xf
    s_nop 0
    s_waitcnt vmcnt(4)
    v_mfma_f32_16x16x32_bf16 v[28:31], v[24:27], v[172:175], v[28:31]
    v_and_b32_dpp v24, v38, v4 row_newbcast:0 row_mask:0xf bank_mask:0xf
    v_and_b32_dpp v25, v38, v5 row_newbcast:0 row_mask:0xf bank_mask:0xf
    v_and_b32_dpp v26, v38, v6 row_newbcast:0 row_mask:0xf bank_mask:0xf
    v_and_b32_dpp v27, v38, v7 row_newbcast:0 row_mask:0xf bank_mask:0xf
    s_nop 0
    s_waitcnt vmcnt(3)
    v_mfma_f32_16x16x32_bf16 v[28:31], v[24:27], v[176:179], v[28:31]
    v_and_b32_dpp v24, v38, v4 row_newbcast:4 row_mask:0xf bank_mask:0xf
    v_and_b32_dpp v25, v38, v5 row_newbcast:4 row_mask:0xf bank_mask:0xf
    v_and_b32_dpp v26, v38, v6 row_newbcast:4 row_mask:0xf bank_mask:0xf
    v_and_b32_dpp v27, v38, v7 row_newbcast:4 row_mask:0xf bank_mask:0xf
    s_nop 0
    s_waitcnt vmcnt(2)
    v_mfma_f32_16x16x32_bf16 v[28:31], v[24:27], v[180:183], v[28:31]
    v_and_b32_dpp v24, v38, v4 row_newbcast:8 row_mask:0xf bank_mask:0xf
    v_and_b32_dpp v25, v38, v5 row_newbcast:8 row_mask:0xf bank_mask:0xf
    v_and_b32_dpp v26, v38, v6 row_newbcast:8 row_mask:0xf bank_mask:0xf
    v_and_b32_dpp v27, v38, v7 row_newbcast:8 row_mask:0xf bank_mask:0xf
    s_nop 0
    s_waitcnt vmcnt(1)
    v_mfma_f32_16x16x32_bf16 v[28:31], v[24:27], v[184:187], v[28:31]
    v_and_b32_dpp v24, v38, v4 row_newbcast:12 row_mask:0xf bank_mask:0xf
    v_and_b32_dpp v25, v38, v5 row_newbcast:12 row_mask:0xf bank_mask:0xf
    v_and_b32_dpp v26, v38, v6 row_newbcast:12 row_mask:0xf bank_mask:0xf
    v_and_b32_dpp v27, v38, v7 row_newbcast:12 row_mask:0xf bank_mask:0xf
    s_nop 0
    s_waitcnt vmcnt(0)
    v_mfma_f32_16x16x32_bf16 v[28:31], v[24:27], v[188:191], v[28:31]
    s_mov_b32 exec_hi, 0
    s_nop 6
    ds_write_b128 v60, v[28:31] offset:7168
    s_mov_b64 exec, -1
    s_waitcnt lgkmcnt(0)
    s_barrier
    s_cmp_eq_u32 s66, 0
    s_cbranch_scc0 L_d1B
    buffer_load_dwordx4 v[192:195], v10, s[68:71], s76 offen
    s_branch L_d1D
L_d1B:
    s_cmp_eq_u32 s66, 1
    s_cbranch_scc0 L_d1D
    buffer_load_dwordx4 v[192:195], v10, s[68:71], s76 offen
    s_add_u32 s76, s76, 163840
L_d1D:
    s_barrier
    s_cmp_lt_u32 s66, 2
    s_cbranch_scc1 L_s_ffn
    s_cmp_eq_u32 s66, 3
    s_cbranch_scc1 L_end
    s_cmp_lg_u32 s3, 0
    s_cbranch_scc1 L_end
    s_mov_b64 s[62:63], exec
    s_mov_b32 s64, 524288
L_poll_4:
    global_load_dwordx4 v[160:163], v52, s[38:39] sc1
    global_load_dwordx4 v[164:167], v53, s[38:39] sc1
    global_load_dwordx4 v[168:171], v54, s[38:39] sc1
    global_load_dwordx4 v[172:175], v55, s[38:39] sc1
    global_load_dwordx4 v[176:179], v56, s[38:39] sc1
    global_load_dwordx4 v[180:183], v57, s[38:39] sc1
    global_load_dwordx4 v[184:187], v58, s[38:39] sc1
    global_load_dwordx4 v[188:191], v59, s[38:39] sc1
    s_waitcnt vmcnt(0)
    v_max3_u32 v32, v160, v161, v162
    v_max3_u32 v32, v32, v163, v164
    v_max3_u32 v32, v32, v165, v166
    v_max3_u32 v32, v32, v167, v168
    v_max3_u32 v32, v32, v169, v170
    v_max3_u32 v32, v32, v171, v172
    v_max3_u32 v32, v32, v173, v174
    v_max3_u32 v32, v32, v175, v176
    v_max3_u32 v32, v32, v177, v178
    v_max3_u32 v32, v32, v179, v180
    v_max3_u32 v32, v32, v181, v182
    v_max3_u32 v32, v32, v183, v184
    v_max3_u32 v32, v32, v185, v186
    v_max3_u32 v32, v32, v187, v188
    v_max3_u32 v32, v32, v189, v190
    v_max_u32 v32, v32, v191
    v_cmpx_eq_u32 vcc, -1, v32
    s_cbranch_execz L_polld_5
    s_sub_u32 s64, s64, 1
    s_cbranch_scc0 L_poll_4
L_polld_5:
    s_mov_b64 exec, s[62:63]
    s_nop 2
    v_pk_add_f32 v[160:161], v[160:161], v[176:177]
    v_pk_add_f32 v[162:163], v[162:163], v[178:179]
    v_pk_add_f32 v[164:165], v[164:165], v[180:181]
    v_pk_add_f32 v[166:167], v[166:167], v[182:183]
    v_pk_add_f32 v[168:169], v[168:169], v[184:185]
    v_pk_add_f32 v[170:171], v[170:171], v[186:187]
    v_pk_add_f32 v[172:173], v[172:173], v[188:189]
    v_pk_add_f32 v[174:175], v[174:175], v[190:191]
    v_pk_add_f32 v[160:161], v[160:161], v[168:169]
    v_pk_add_f32 v[162:163], v[162:163], v[170:171]
    v_pk_add_f32 v[164:165], v[164:165], v[172:173]
    v_pk_add_f32 v[166:167], v[166:167], v[174:175]
    v_pk_add_f32 v[160:161], v[160:161], v[164:165]
    v_pk_add_f32 v[162:163], v[162:163], v[166:167]
    v_mov_b32 v164, v160
    v_mov_b32 v165, v161
    v_mov_b32 v166, v162
    v_mov_b32 v167, v163
    v_permlane16_swap_b32 v160, v164
    v_permlane16_swap_b32 v161, v165
    v_permlane16_swap_b32 v162, v166
    v_permlane16_swap_b32 v163, v167
    v_pk_add_f32 v[160:161], v[160:161], v[164:165]
    v_pk_add_f32 v[162:163], v[162:163], v[166:167]
    s_nop 0
    v_mov_b32 v164, v160
    v_mov_b32 v165, v161
    v_mov_b32 v166, v162
    v_mov_b32 v167, v163
    v_permlane32_swap_b32 v160, v164
    v_permlane32_swap_b32 v161, v165
    v_permlane32_swap_b32 v162, v166
    v_permlane32_swap_b32 v163, v167
    v_pk_add_f32 v[160:161], v[160:161], v[164:165]
    v_pk_add_f32 v[162:163], v[162:163], v[166:167]
    s_nop 0
    v_cvt_pk_bf16_f32 v24, v160, v161
    v_cvt_pk_bf16_f32 v26, v162, v163
    v_lshlrev_b32 v28, 16, v24
    v_and_b32 v29, 0xffff0000, v24
    v_lshlrev_b32 v30, 16, v26
    v_and_b32 v31, 0xffff0000, v26
    v_lshlrev_b32 v24, 16, v42
    v_and_b32 v25, 0xffff0000, v42
    v_lshlrev_b32 v26, 16, v43
    v_and_b32 v27, 0xffff0000, v43
    v_add_f32 v24, v24, v28
    v_add_f32 v25, v25, v29
    v_add_f32 v26, v26, v30
    v_add_f32 v27, v27, v31
    v_cvt_pk_bf16_f32 v24, v24, v25
    v_cvt_pk_bf16_f32 v25, v26, v27
    v_min_u32 v24, -2, v24
    v_min_u32 v25, -2, v25
    s_nop 0
    v_mov_b32_dpp v26, v24 quad_perm:[1,1,3,3] row_mask:0xf bank_mask:0xf
    v_mov_b32_dpp v27, v25 quad_perm:[1,1,3,3] row_mask:0xf bank_mask:0xf
    s_mov_b64 exec, 0x5555
    global_store_dwordx4 v44, v[24:27], s[38:39] sc1
    s_endpgm
L_s_ffn:
    s_barrier
    s_cmp_eq_u32 s66, 0
    s_cbranch_scc0 L_d2B
    buffer_load_dwordx4 v[196:199], v10, s[72:75], s76 offen
    s_add_u32 s76, s76, 442368
    buffer_load_dwordx4 v[200:203], v10, s[68:71], s76 offen
    buffer_load_dwordx4 v[204:207], v10, s[72:75], s76 offen
    s_add_u32 s76, s76, 442368
    buffer_load_dwordx4 v[208:211], v10, s[68:71], s76 offen
    buffer_load_dwordx4 v[212:215], v10, s[72:75], s76 offen
    s_add_u32 s76, s76, 442368
    buffer_load_dwordx4 v[216:219], v10, s[68:71], s76 offen
    buffer_load_dwordx4 v[220:223], v10, s[72:75], s76 offen
    s_add_u32 s76, s76, 442368
    buffer_load_dwordx4 v[224:227], v10, s[68:71], s76 offen
    buffer_load_dwordx4 v[228:231], v10, s[72:75], s76 offen
    s_add_u32 s76, s76, 442368
    s_waitcnt vmcnt(8)
    ds_write2_b32 v11, v192, v196 offset0:0 offset1:1
    ds_write2_b32 v11, v193, v197 offset0:2 offset1:3
    ds_write2_b32 v11, v194, v198 offset0:4 offset1:5
    ds_write2_b32 v11, v195, v199 offset0:6 offset1:7
    v_add_u32 v11, 8192, v11
    s_waitcnt vmcnt(6)
    ds_write2_b32 v11, v200, v204 offset0:0 offset1:1
    ds_write2_b32 v11, v201, v205 offset0:2 offset1:3
    ds_write2_b32 v11, v202, v206 offset0:4 offset1:5
    ds_write2_b32 v11, v203, v207 offset0:6 offset1:7
    v_add_u32 v11, 8192, v11
    s_waitcnt vmcnt(4)
    ds_write2_b32 v11, v208, v212 offset0:0 offset1:1
    ds_write2_b32 v11, v209, v213 offset0:2 offset1:3
    ds_write2_b32 v11, v210, v214 offset0:4 offset1:5
    ds_write2_b32 v11, v211, v215 offset0:6 offset1:7
    v_add_u32 v11, 8192, v11
    s_waitcnt vmcnt(2)
    ds_write2_b32 v11, v216, v220 offset0:0 offset1:1
    ds_write2_b32 v11, v217, v221 offset0:2 offset1:3
    ds_write2_b32 v11, v218, v222 offset0:4 offset1:5
    ds_write2_b32 v11, v219, v223 offset0:6 offset1:7
    v_add_u32 v11, 8192, v11
    s_waitcnt vmcnt(0)
    ds_write2_b32 v11, v224, v228 offset0:0 offset1:1
    ds_write2_b32 v11, v225, v229 offset0:2 offset1:3
    ds_write2_b32 v11, v226, v230 offset0:4 offset1:5
    ds_write2_b32 v11, v227, v231 offset0:6 offset1:7
    s_branch L_d2D
L_d2B:
    buffer_load_dwordx4 v[196:199], v10, s[68:71], s76 offen
    s_add_u32 s76, s76, 163840
    buffer_load_dwordx4 v[200:203], v10, s[68:71], s76 offen
    s_add_u32 s76, s76, 163840
    buffer_load_dwordx4 v[204:207], v10, s[68:71], s76 offen
    s_add_u32 s76, s76, 163840
    buffer_load_dwordx4 v[208:211], v10, s[68:71], s76 offen
    s_add_u32 s76, s76, 163840
    buffer_load_dwordx4 v[212:215], v10, s[68:71], s76 offen
    s_add_u32 s76, s76, 163840
    buffer_load_dwordx4 v[216:219], v10, s[68:71], s76 offen
    s_add_u32 s76, s76, 163840
    buffer_load_dwordx4 v[220:223], v10, s[68:71], s76 offen
    s_add_u32 s76, s76, 163840
    buffer_load_dwordx4 v[224:227], v10, s[68:71], s76 offen
    s_add_u32 s76, s76, 163840
    buffer_load_dwordx4 v[228:231], v10, s[68:71], s76 offen
    s_add_u32 s76, s76, 163840
    buffer_load_dwordx4 v[232:235], v10, s[68:71], s76 offen
    s_add_u32 s76, s76, 163840
    buffer_load_dwordx4 v[236:239], v10, s[68:71], s76 offen
    s_add_u32 s76, s76, 163840
    buffer_load_dwordx4 v[240:243], v10, s[68:71], s76 offen
    s_add_u32 s76, s76, 163840
    buffer_load_dwordx4 v[244:247], v10, s[68:71], s76 offen
    s_add_u32 s76, s76, 163840
    s_waitcnt vmcnt(13)
    ds_write_b128 v11, v[192:195] offset:0
    s_waitcnt vmcnt(12)
    ds_write_b128 v11, v[196:199] offset:4096
    s_waitcnt vmcnt(11)
    ds_write_b128 v11, v[200:203] offset:8192
    s_waitcnt vmcnt(10)
    ds_write_b128 v11, v[204:207] offset:12288
    s_waitcnt vmcnt(9)
    ds_write_b128 v11, v[208:211] offset:16384
    s_waitcnt vmcnt(8)
    ds_write_b128 v11, v[212:215] offset:20480
    s_waitcnt vmcnt(7)
    ds_write_b128 v11, v[216:219] offset:24576
    s_waitcnt vmcnt(6)
    ds_write_b128 v11, v[220:223] offset:28672
    s_waitcnt vmcnt(5)
    ds_write_b128 v11, v[224:227] offset:32768
    s_waitcnt vmcnt(4)
    ds_write_b128 v11, v[228:231] offset:36864
    s_waitcnt vmcnt(3)
    ds_write_b128 v11, v[232:235] offset:40960
    s_waitcnt vmcnt(2)
    ds_write_b128 v11, v[236:239] offset:45056
    s_waitcnt vmcnt(1)
    ds_write_b128 v11, v[240:243] offset:49152
    s_waitcnt vmcnt(0)
    ds_write_b128 v11, v[244:247] offset:53248
L_d2D:
    s_waitcnt lgkmcnt(0)
    s_barrier
    v_lshrrev_b32 v46, 4, v1
    v_lshlrev_b32 v46, 3, v46
    v_bfe_u32 v47, v1, 2, 2
    v_add_u32 v46, v46, v47
    v_and_b32 v47, 3, v1
    v_lshlrev_b32 v47, 3, v47
    v_add_u32 v47, 46336, v47
    s_cmp_eq_u32 s66, 0
    s_cbranch_scc1 L_wa_6
    v_lshl_add_u32 v46, v46, 5, v47
    s_lshl_b32 s7, s3, 10
    v_add_u32 v46, s7, v46
    ds_read_b64_tr_b16 v[64:65], v46 offset:0
    ds_read_b64_tr_b16 v[66:67], v46 offset:128
    ds_read_b64_tr_b16 v[68:69], v46 offset:8192
    ds_read_b64_tr_b16 v[70:71], v46 offset:8320
    ds_read_b64_tr_b16 v[72:73], v46 offset:16384
    ds_read_b64_tr_b16 v[74:75], v46 offset:16512
    ds_read_b64_tr_b16 v[76:77], v46 offset:24576
    ds_read_b64_tr_b16 v[78:79], v46 offset:24704
    ds_read_b64_tr_b16 v[80:81], v46 offset:32768
    ds_read_b64_tr_b16 v[82:83], v46 offset:32896
    ds_read_b64_tr_b16 v[84:85], v46 offset:40960
    ds_read_b64_tr_b16 v[86:87], v46 offset:41088
    ds_read_b64_tr_b16 v[88:89], v46 offset:49152
    ds_read_b64_tr_b16 v[90:91], v46 offset:49280
    s_branch L_wd_7
L_wa_6:
    s_cmp_lt_u32 s3, 2
    s_cbranch_scc1 L_wd_7
    v_lshl_add_u32 v46, v46, 6, v47
    s_sub_u32 s7, s3, 2
    s_lshl_b32 s7, s7, 5
    v_add_u32 v46, s7, v46
    ds_read_b64_tr_b16 v[64:65], v46 offset:0
    ds_read_b64_tr_b16 v[66:67], v46 offset:256
    ds_read_b64_tr_b16 v[68:69], v46 offset:2048
    ds_read_b64_tr_b16 v[70:71], v46 offset:2304
    ds_read_b64_tr_b16 v[72:73], v46 offset:4096
    ds_read_b64_tr_b16 v[74:75], v46 offset:4352
    ds_read_b64_tr_b16 v[76:77], v46 offset:6144
    ds_read_b64_tr_b16 v[78:79], v46 offset:6400
    ds_read_b64_tr_b16 v[80:81], v46 offset:8192
    ds_read_b64_tr_b16 v[82:83], v46 offset:8448
    ds_read_b64_tr_b16 v[84:85], v46 offset:10240
    ds_read_b64_tr_b16 v[86:87], v46 offset:10496
    ds_read_b64_tr_b16 v[88:89], v46 offset:12288
    ds_read_b64_tr_b16 v[90:91], v46 offset:12544
    ds_read_b64_tr_b16 v[92:93], v46 offset:14336
    ds_read_b64_tr_b16 v[94:95], v46 offset:14592
    ds_read_b64_tr_b16 v[96:97], v46 offset:16384
    ds_read_b64_tr_b16 v[98:99], v46 offset:16640
    ds_read_b64_tr_b16 v[100:101], v46 offset:18432
    ds_read_b64_tr_b16 v[102:103], v46 offset:18688
    ds_read_b64_tr_b16 v[104:105], v46 offset:20480
    ds_read_b64_tr_b16 v[106:107], v46 offset:20736
    ds_read_b64_tr_b16 v[108:109], v46 offset:22528
    ds_read_b64_tr_b16 v[110:111], v46 offset:22784
    ds_read_b64_tr_b16 v[112:113], v46 offset:24576
    ds_read_b64_tr_b16 v[114:115], v46 offset:24832
    ds_read_b64_tr_b16 v[116:117], v46 offset:26624
    ds_read_b64_tr_b16 v[118:119], v46 offset:26880
    ds_read_b64_tr_b16 v[120:121], v46 offset:28672
    ds_read_b64_tr_b16 v[122:123], v46 offset:28928
    ds_read_b64_tr_b16 v[124:125], v46 offset:30720
    ds_read_b64_tr_b16 v[126:127], v46 offset:30976
    ds_read_b64_tr_b16 v[128:129], v46 offset:32768
    ds_read_b64_tr_b16 v[130:131], v46 offset:33024
    ds_read_b64_tr_b16 v[132:133], v46 offset:34816
    ds_read_b64_tr_b16 v[134:135], v46 offset:35072
    ds_read_b64_tr_b16 v[136:137], v46 offset:36864
    ds_read_b64_tr_b16 v[138:139], v46 offset:37120
    ds_read_b64_tr_b16 v[140:141], v46 offset:38912
    ds_read_b64_tr_b16 v[142:143], v46 offset:39168
L_wd_7:
    s_branch L_tail
L_helper:
    s_sub_u32 s9, s3, 4
    v_lshrrev_b32 v2, 4, v1
    v_mul_u32_u24 v2, 40, v2
    s_mul_i32 s7, s9, 160
    v_add_u32 v3, s7, v2
    v_lshlrev_b32 v2, 13, v3
    v_and_b32 v8, 15, v1
    v_lshl_add_u32 v2, v8, 4, v2
    v_lshlrev_b32 v3, 3, v3
    s_mul_i32 s49, s4, 5
    s_lshr_b32 s49, s49, 2
    s_lshl_b32 s49, s49, 4
    v_add_u32 v3, s49, v3
    v_lshlrev_b32 v26, 4, v1
    v_lshlrev_b32 v27, 2, v1
    s_mul_i32 s7, s4, 1280
    s_lshl_b32 s8, s5, 8
    s_mov_b32 s47, 0x20000
    s_sub_u32 s46, 5242880, s8
    s_lshl_b32 s48, s49, 11
    s_waitcnt lgkmcnt(0)
    s_add_u32 s10, s16, s7
    s_addc_u32 s11, s17, 0
    s_add_u32 s44, s22, s8
    s_addc_u32 s45, s23, 0
    s_load_dword s77, s[38:39], 726016
    s_and_b32 s12, s2, 7
    s_lshr_b32 s13, s2, 3
    s_min_u32 s14, s12, 3
    s_lshl_b32 s14, s14, 2
    s_mul_i32 s67, s12, 12
    s_add_u32 s67, s67, s14
    s_add_u32 s67, s67, s13
    s_cmp_lt_u32 s12, 3
    s_cselect_b32 s14, 16, 12
    s_mov_b32 s66, 0
    s_sub_u32 s13, s13, s14
    s_cbranch_scc1 L_role7
    s_sub_u32 s14, s12, 3
    s_max_i32 s14, s14, 0
    s_min_i32 s14, s14, 2
    s_add_u32 s14, s14, s12
    s_lshl_b32 s14, s14, 2
    s_add_u32 s67, s14, s13
    s_sub_u32 s14, s12, 3
    s_cmp_lt_u32 s14, 2
    s_cselect_b32 s14, 8, 4
    s_mov_b32 s66, 1
    s_sub_u32 s13, s13, s14
    s_cbranch_scc1 L_role7
    s_mov_b32 s67, s13
    s_mov_b32 s66, 2
    s_cmp_lt_u32 s13, 10
    s_cbranch_scc1 L_role7
    s_mov_b32 s66, 3
    s_mov_b32 s67, 0
L_role7:
    v_mov_b32 v20, -1
    v_mov_b32 v21, -1
    v_mov_b32 v22, -1
    v_mov_b32 v23, -1
    s_mul_i32 s7, s2, 2560
    v_add_u32 v24, s7, v26
    s_lshl_b32 s8, s9, 10
    v_add_u32 v45, s8, v24
    s_mul_i32 s7, s12, 1280
    s_lshl_b32 s8, s67, 7
    s_add_u32 s7, s7, s8
    s_add_u32 s7, s7, 655360
    s_lshl_b32 s8, s67, 8
    s_add_u32 s8, s8, 665600
    s_cmp_eq_u32 s66, 0
    s_cselect_b32 s7, s8, s7
    v_add_u32 v25, s7, v27
    s_cmp_lg_u32 s9, 3
    s_cbranch_scc1 L_clrd
    global_store_dwordx4 v24, v[20:23], s[38:39] sc1
    global_store_dwordx4 v24, v[20:23], s[38:39] offset:1024 sc1
    global_store_dwordx4 v24, v[20:23], s[38:39] offset:1536 sc1
L_nopc:
    s_bitcmp1_b32 s66, 0
    s_cbranch_scc1 L_clrd
    s_cmp_eq_u32 s66, 0
    s_cselect_b32 exec_hi, -1, 0
    global_store_dword v25, v20, s[38:39] sc1
    s_mov_b64 exec, -1
L_clrd:
    global_load_dwordx4 v[12:15], v26, s[10:11]
    global_load_dword v16, v27, s[10:11] offset:1024
    buffer_load_dwordx4 v[96:99], v2, s[44:47], s48 offen
    s_add_u32 s48, s48, 8192
    buffer_load_dwordx4 v[100:103], v2, s[44:47], s48 offen
    s_add_u32 s48, s48, 8192
    buffer_load_dwordx4 v[104:107], v2, s[44:47], s48 offen
    s_add_u32 s48, s48, 8192
    buffer_load_dwordx4 v[108:111], v2, s[44:47], s48 offen
    s_add_u32 s48, s48, 8192
    s_cmp_eq_u32 s48, 327680
    s_cselect_b32 s48, 0, s48
    buffer_load_dwordx4 v[112:115], v2, s[44:47], s48 offen
    s_add_u32 s48, s48, 8192
    buffer_load_dwordx4 v[116:119], v2, s[44:47], s48 offen
    s_add_u32 s48, s48, 8192
    buffer_load_dwordx4 v[120:123], v2, s[44:47], s48 offen
    s_add_u32 s48, s48, 8192
    buffer_load_dwordx4 v[124:127], v2, s[44:47], s48 offen
    s_add_u32 s48, s48, 8192
    s_cmp_eq_u32 s48, 327680
    s_cselect_b32 s48, 0, s48
    v_and_b32 v8, 15, v1
    v_and_b32 v9, 1, v1
    v_lshlrev_b32 v9, 4, v9
    v_mov_b32 v10, 0xffff
    v_lshlrev_b32 v10, v9, v10
    v_lshrrev_b32 v11, 1, v8
    v_cmp_eq_u32 vcc, 0, v11
    s_nop 1
    v_cndmask_b32 v4, 0, v10, vcc
    v_cmp_eq_u32 vcc, 1, v11
    s_nop 1
    v_cndmask_b32 v5, 0, v10, vcc
    v_cmp_eq_u32 vcc, 2, v11
    s_nop 1
    v_cndmask_b32 v6, 0, v10, vcc
    v_cmp_eq_u32 vcc, 3, v11
    s_nop 1
    v_cndmask_b32 v7, 0, v10, vcc
    v_mul_u32_u24 v8, 52429, v1
    v_lshrrev_b32 v8, 18, v8
    v_mul_u32_u24 v8, 160, v8
    v_lshl_add_u32 v8, v1, 5, v8
    v_add_u32 v9, 256, v1
    v_mul_u32_u24 v10, 52429, v9
    v_lshrrev_b32 v10, 20, v10
    v_mul_u32_u24 v10, 160, v10
    v_lshl_add_u32 v9, v9, 3, v10
    s_waitcnt vmcnt(8)
    v_lshlrev_b32 v28, 16, v12
    v_and_b32 v29, 0xffff0000, v12
    v_lshlrev_b32 v30, 16, v13
    v_and_b32 v31, 0xffff0000, v13
    v_lshlrev_b32 v32, 16, v14
    v_and_b32 v33, 0xffff0000, v14
    v_lshlrev_b32 v34, 16, v15
    v_and_b32 v35, 0xffff0000, v15
    v_lshlrev_b32 v36, 16, v16
    v_and_b32 v37, 0xffff0000, v16
    s_mov_b32 s61, 0x3acccccd
    v_add_f32 v40, v28, v29
    v_add_f32 v40, v40, v30
    v_add_f32 v40, v40, v31
    v_add_f32 v40, v40, v32
    v_add_f32 v40, v40, v33
    v_add_f32 v40, v40, v34
    v_add_f32 v40, v40, v35
    v_add_f32 v40, v40, v36
    v_add_f32 v40, v40, v37
    s_nop 1
    v_add_f32_dpp v40, v40, v40 row_ror:8 row_mask:0xf bank_mask:0xf
    s_nop 1
    v_add_f32_dpp v40, v40, v40 row_ror:4 row_mask:0xf bank_mask:0xf
    s_nop 1
    v_add_f32_dpp v40, v40, v40 row_ror:2 row_mask:0xf bank_mask:0xf
    s_nop 1
    v_add_f32_dpp v40, v40, v40 row_ror:1 row_mask:0xf bank_mask:0xf
    s_nop 1
    v_add_f32_dpp v40, v40, v40 row_bcast:15 row_mask:0xa bank_mask:0xf
    s_nop 1
    v_add_f32_dpp v40, v40, v40 row_bcast:31 row_mask:0xc bank_mask:0xf
    s_nop 1
    v_readlane_b32 s60, v40, 63
    s_nop 1
    v_mov_b32 v40, s60
    v_mul_f32 v40, s61, v40
    v_sub_f32 v41, v28, v40
    v_mul_f32 v42, v41, v41
    v_sub_f32 v41, v29, v40
    v_fmac_f32 v42, v41, v41
    v_sub_f32 v41, v30, v40
    v_fmac_f32 v42, v41, v41
    v_sub_f32 v41, v31, v40
    v_fmac_f32 v42, v41, v41
    v_sub_f32 v41, v32, v40
    v_fmac_f32 v42, v41, v41
    v_sub_f32 v41, v33, v40
    v_fmac_f32 v42, v41, v41
    v_sub_f32 v41, v34, v40
    v_fmac_f32 v42, v41, v41
    v_sub_f32 v41, v35, v40
    v_fmac_f32 v42, v41, v41
    v_sub_f32 v41, v36, v40
    v_fmac_f32 v42, v41, v41
    v_sub_f32 v41, v37, v40
    v_fmac_f32 v42, v41, v41
    s_nop 1
    v_add_f32_dpp v42, v42, v42 row_ror:8 row_mask:0xf bank_mask:0xf
    s_nop 1
    v_add_f32_dpp v42, v42, v42 row_ror:4 row_mask:0xf bank_mask:0xf
    s_nop 1
    v_add_f32_dpp v42, v42, v42 row_ror:2 row_mask:0xf bank_mask:0xf
    s_nop 1
    v_add_f32_dpp v42, v42, v42 row_ror:1 row_mask:0xf bank_mask:0xf
    s_nop 1
    v_add_f32_dpp v42, v42, v42 row_bcast:15 row_mask:0xa bank_mask:0xf
    s_nop 1
    v_add_f32_dpp v42, v42, v42 row_bcast:31 row_mask:0xc bank_mask:0xf
    s_nop 1
    v_readlane_b32 s60, v42, 63
    v_cvt_pk_bf16_f32 v40, v40, v40
    v_lshlrev_b32 v40, 16, v40
    v_mov_b32 v42, s60
    v_mul_f32 v42, s61, v42
    v_cvt_pk_bf16_f32 v42, v42, v42
    v_lshlrev_b32 v42, 16, v42
    v_add_f32 v42, 0x3727c5ac, v42
    v_cvt_pk_bf16_f32 v42, v42, v42
    v_lshlrev_b32 v42, 16, v42
    v_sqrt_f32 v42, v42
    v_sub_f32 v28, v28, v40
    v_sub_f32 v29, v29, v40
    v_sub_f32 v30, v30, v40
    v_sub_f32 v31, v31, v40
    v_sub_f32 v32, v32, v40
    v_sub_f32 v33, v33, v40
    v_sub_f32 v34, v34, v40
    v_sub_f32 v35, v35, v40
    v_sub_f32 v36, v36, v40
    v_sub_f32 v37, v37, v40
    v_cvt_pk_bf16_f32 v42, v42, v42
    v_lshlrev_b32 v42, 16, v42
    v_rcp_f32 v43, v42
    v_cvt_pk_bf16_f32 v20, v28, v29
    v_cvt_pk_bf16_f32 v21, v30, v31
    v_cvt_pk_bf16_f32 v22, v32, v33
    v_cvt_pk_bf16_f32 v23, v34, v35
    v_cvt_pk_bf16_f32 v24, v36, v37
    v_lshlrev_b32 v28, 16, v20
    v_and_b32 v29, 0xffff0000, v20
    v_lshlrev_b32 v30, 16, v21
    v_and_b32 v31, 0xffff0000, v21
    v_lshlrev_b32 v32, 16, v22
    v_and_b32 v33, 0xffff0000, v22
    v_lshlrev_b32 v34, 16, v23
    v_and_b32 v35, 0xffff0000, v23
    v_lshlrev_b32 v36, 16, v24
    v_and_b32 v37, 0xffff0000, v24
    v_mul_f32 v40, v28, v43
    v_fma_f32 v41, -v40, v42, v28
    v_fma_f32 v28, v41, v43, v40
    v_mul_f32 v40, v29, v43
    v_fma_f32 v41, -v40, v42, v29
    v_fma_f32 v29, v41, v43, v40
    v_mul_f32 v40, v30, v43
    v_fma_f32 v41, -v40, v42, v30
    v_fma_f32 v30, v41, v43, v40
    v_mul_f32 v40, v31, v43
    v_fma_f32 v41, -v40, v42, v31
    v_fma_f32 v31, v41, v43, v40
    v_mul_f32 v40, v32, v43
    v_fma_f32 v41, -v40, v42, v32
    v_fma_f32 v32, v41, v43, v40
    v_mul_f32 v40, v33, v43
    v_fma_f32 v41, -v40, v42, v33
    v_fma_f32 v33, v41, v43, v40
    v_mul_f32 v40, v34, v43
    v_fma_f32 v41, -v40, v42, v34
    v_fma_f32 v34, v41, v43, v40
    v_mul_f32 v40, v35, v43
    v_fma_f32 v41, -v40, v42, v35
    v_fma_f32 v35, v41, v43, v40
    v_mul_f32 v40, v36, v43
    v_fma_f32 v41, -v40, v42, v36
    v_fma_f32 v36, v41, v43, v40
    v_mul_f32 v40, v37, v43
    v_fma_f32 v41, -v40, v42, v37
    v_fma_f32 v37, v41, v43, v40
    v_cvt_pk_bf16_f32 v28, v28, v28
    v_cvt_pk_bf16_f32 v29, v29, v29
    v_cvt_pk_bf16_f32 v30, v30, v30
    v_cvt_pk_bf16_f32 v31, v31, v31
    v_cvt_pk_bf16_f32 v32, v32, v32
    v_cvt_pk_bf16_f32 v33, v33, v33
    v_cvt_pk_bf16_f32 v34, v34, v34
    v_cvt_pk_bf16_f32 v35, v35, v35
    v_cvt_pk_bf16_f32 v36, v36, v36
    v_cvt_pk_bf16_f32 v37, v37, v37
    ds_write_b128 v8, v[28:31] offset:0
    ds_write_b128 v8, v[32:35] offset:16
    ds_write_b64 v9, v[36:37] offset:0
    ds_write_b128 v8, v[28:31] offset:160
    ds_write_b128 v8, v[32:35] offset:176
    ds_write_b64 v9, v[36:37] offset:160
    s_waitcnt lgkmcnt(0)
    ds_read_b128 v[48:51], v3 offset:0
    ds_read_b128 v[52:55], v3 offset:16
    ds_read_b128 v[56:59], v3 offset:32
    ds_read_b128 v[60:63], v3 offset:48
    ds_read_b128 v[64:67], v3 offset:64
    ds_read_b128 v[68:71], v3 offset:80
    ds_read_b128 v[72:75], v3 offset:96
    ds_read_b128 v[76:79], v3 offset:112
    ds_read_b128 v[80:83], v3 offset:128
    ds_read_b128 v[84:87], v3 offset:144
    buffer_load_dwordx4 v[128:131], v2, s[44:47], s48 offen
    s_add_u32 s48, s48, 8192
    buffer_load_dwordx4 v[132:135], v2, s[44:47], s48 offen
    s_add_u32 s48, s48, 8192
    buffer_load_dwordx4 v[136:139], v2, s[44:47], s48 offen
    s_add_u32 s48, s48, 8192
    buffer_load_dwordx4 v[140:143], v2, s[44:47], s48 offen
    s_add_u32 s48, s48, 8192
    s_cmp_eq_u32 s48, 327680
    s_cselect_b32 s48, 0, s48
    buffer_load_dwordx4 v[144:147], v2, s[44:47], s48 offen
    s_add_u32 s48, s48, 8192
    buffer_load_dwordx4 v[148:151], v2, s[44:47], s48 offen
    s_add_u32 s48, s48, 8192
    buffer_load_dwordx4 v[152:155], v2, s[44:47], s48 offen
    s_add_u32 s48, s48, 8192
    buffer_load_dwordx4 v[156:159], v2, s[44:47], s48 offen
    s_add_u32 s48, s48, 8192
    s_cmp_eq_u32 s48, 327680
    s_cselect_b32 s48, 0, s48
    buffer_load_dwordx4 v[160:163], v2, s[44:47], s48 offen
    s_add_u32 s48, s48, 8192
    buffer_load_dwordx4 v[164:167], v2, s[44:47], s48 offen
    s_add_u32 s48, s48, 8192
    buffer_load_dwordx4 v[168:171], v2, s[44:47], s48 offen
    s_add_u32 s48, s48, 8192
    buffer_load_dwordx4 v[172:175], v2, s[44:47], s48 offen
    s_add_u32 s48, s48, 8192
    s_cmp_eq_u32 s48, 327680
    s_cselect_b32 s48, 0, s48
    buffer_load_dwordx4 v[176:179], v2, s[44:47], s48 offen
    s_add_u32 s48, s48, 8192
    buffer_load_dwordx4 v[180:183], v2, s[44:47], s48 offen
    s_add_u32 s48, s48, 8192
    buffer_load_dwordx4 v[184:187], v2, s[44:47], s48 offen
    s_add_u32 s48, s48, 8192
    buffer_load_dwordx4 v[188:191], v2, s[44:47], s48 offen
    s_add_u32 s48, s48, 8192
    s_cmp_eq_u32 s48, 327680
    s_cselect_b32 s48, 0, s48
    buffer_load_dwordx4 v[192:195], v2, s[44:47], s48 offen
    s_add_u32 s48, s48, 8192
    buffer_load_dwordx4 v[196:199], v2, s[44:47], s48 offen
    s_add_u32 s48, s48, 8192
    buffer_load_dwordx4 v[200:203], v2, s[44:47], s48 offen
    s_add_u32 s48, s48, 8192
    buffer_load_dwordx4 v[204:207], v2, s[44:47], s48 offen
    s_add_u32 s48, s48, 8192
    s_cmp_eq_u32 s48, 327680
    s_cselect_b32 s48, 0, s48
    buffer_load_dwordx4 v[208:211], v2, s[44:47], s48 offen
    s_add_u32 s48, s48, 8192
    buffer_load_dwordx4 v[212:215], v2, s[44:47], s48 offen
    s_add_u32 s48, s48, 8192
    buffer_load_dwordx4 v[216:219], v2, s[44:47], s48 offen
    s_add_u32 s48, s48, 8192
    buffer_load_dwordx4 v[220:223], v2, s[44:47], s48 offen
    s_add_u32 s48, s48, 8192
    s_cmp_eq_u32 s48, 327680
    s_cselect_b32 s48, 0, s48
    buffer_load_dwordx4 v[224:227], v2, s[44:47], s48 offen
    s_add_u32 s48, s48, 8192
    buffer_load_dwordx4 v[228:231], v2, s[44:47], s48 offen
    s_add_u32 s48, s48, 8192
    buffer_load_dwordx4 v[232:235], v2, s[44:47], s48 offen
    s_add_u32 s48, s48, 8192
    buffer_load_dwordx4 v[236:239], v2, s[44:47], s48 offen
    s_add_u32 s48, s48, 8192
    s_cmp_eq_u32 s48, 327680
    s_cselect_b32 s48, 0, s48
    buffer_load_dwordx4 v[240:243], v2, s[44:47], s48 offen
    s_add_u32 s48, s48, 8192
    buffer_load_dwordx4 v[244:247], v2, s[44:47], s48 offen
    s_add_u32 s48, s48, 8192
    buffer_load_dwordx4 v[248:251], v2, s[44:47], s48 offen
    s_add_u32 s48, s48, 8192
    buffer_load_dwordx4 v[252:255], v2, s[44:47], s48 offen
    s_waitcnt lgkmcnt(0)
    v_and_b32 v28, v48, v4
    v_and_b32 v29, v48, v5
    v_and_b32 v30, v48, v6
    v_and_b32 v31, v48, v7
    s_waitcnt vmcnt(39)
    s_nop 0
    v_mfma_f32_16x16x32_bf16 v[20:23], v[28:31], v[96:99], 0
    v_and_b32 v32, v49, v4
    v_and_b32 v33, v49, v5
    v_and_b32 v34, v49, v6
    v_and_b32 v35, v49, v7
    s_waitcnt vmcnt(38)
    s_nop 0
    v_mfma_f32_16x16x32_bf16 v[20:23], v[32:35], v[100:103], v[20:23]
    v_and_b32 v28, v50, v4
    v_and_b32 v29, v50, v5
    v_and_b32 v30, v50, v6
    v_and_b32 v31, v50, v7
    s_waitcnt vmcnt(37)
    s_nop 0
    v_mfma_f32_16x16x32_bf16 v[20:23], v[28:31], v[104:107], v[20:23]
    v_and_b32 v32, v51, v4
    v_and_b32 v33, v51, v5
    v_and_b32 v34, v51, v6
    v_and_b32 v35, v51, v7
    s_waitcnt vmcnt(36)
    s_nop 0
    v_mfma_f32_16x16x32_bf16 v[20:23], v[32:35], v[108:111], v[20:23]
    v_and_b32 v28, v52, v4
    v_and_b32 v29, v52, v5
    v_and_b32 v30, v52, v6
    v_and_b32 v31, v52, v7
    s_waitcnt vmcnt(35)
    s_nop 0
    v_mfma_f32_16x16x32_bf16 v[20:23], v[28:31], v[112:115], v[20:23]
    v_and_b32 v32, v53, v4
    v_and_b32 v33, v53, v5
    v_and_b32 v34, v53, v6
    v_and_b32 v35, v53, v7
    s_waitcnt vmcnt(34)
    s_nop 0
    v_mfma_f32_16x16x32_bf16 v[20:23], v[32:35], v[116:119], v[20:23]
    v_and_b32 v28, v54, v4
    v_and_b32 v29, v54, v5
    v_and_b32 v30, v54, v6
    v_and_b32 v31, v54, v7
    s_waitcnt vmcnt(33)
    s_nop 0
    v_mfma_f32_16x16x32_bf16 v[20:23], v[28:31], v[120:123], v[20:23]
    v_and_b32 v32, v55, v4
    v_and_b32 v33, v55, v5
    v_and_b32 v34, v55, v6
    v_and_b32 v35, v55, v7
    s_waitcnt vmcnt(32)
    s_nop 0
    v_mfma_f32_16x16x32_bf16 v[20:23], v[32:35], v[124:127], v[20:23]
    v_and_b32 v28, v56, v4
    v_and_b32 v29, v56, v5
    v_and_b32 v30, v56, v6
    v_and_b32 v31, v56, v7
    s_waitcnt vmcnt(31)
    s_nop 0
    v_mfma_f32_16x16x32_bf16 v[20:23], v[28:31], v[128:131], v[20:23]
    v_and_b32 v32, v57, v4
    v_and_b32 v33, v57, v5
    v_and_b32 v34, v57, v6
    v_and_b32 v35, v57, v7
    s_waitcnt vmcnt(30)
    s_nop 0
    v_mfma_f32_16x16x32_bf16 v[20:23], v[32:35], v[132:135], v[20:23]
    v_and_b32 v28, v58, v4
    v_and_b32 v29, v58, v5
    v_and_b32 v30, v58, v6
    v_and_b32 v31, v58, v7
    s_waitcnt vmcnt(29)
    s_nop 0
    v_mfma_f32_16x16x32_bf16 v[20:23], v[28:31], v[136:139], v[20:23]
    v_and_b32 v32, v59, v4
    v_and_b32 v33, v59, v5
    v_and_b32 v34, v59, v6
    v_and_b32 v35, v59, v7
    s_waitcnt vmcnt(28)
    s_nop 0
    v_mfma_f32_16x16x32_bf16 v[20:23], v[32:35], v[140:143], v[20:23]
    v_and_b32 v28, v60, v4
    v_and_b32 v29, v60, v5
    v_and_b32 v30, v60, v6
    v_and_b32 v31, v60, v7
    s_waitcnt vmcnt(27)
    s_nop 0
    v_mfma_f32_16x16x32_bf16 v[20:23], v[28:31], v[144:147], v[20:23]
    v_and_b32 v32, v61, v4
    v_and_b32 v33, v61, v5
    v_and_b32 v34, v61, v6
    v_and_b32 v35, v61, v7
    s_waitcnt vmcnt(26)
    s_nop 0
    v_mfma_f32_16x16x32_bf16 v[20:23], v[32:35], v[148:151], v[20:23]
    v_and_b32 v28, v62, v4
    v_and_b32 v29, v62, v5
    v_and_b32 v30, v62, v6
    v_and_b32 v31, v62, v7
    s_waitcnt vmcnt(25)
    s_nop 0
    v_mfma_f32_16x16x32_bf16 v[20:23], v[28:31], v[152:155], v[20:23]
    v_and_b32 v32, v63, v4
    v_and_b32 v33, v63, v5
    v_and_b32 v34, v63, v6
    v_and_b32 v35, v63, v7
    s_waitcnt vmcnt(24)
    s_nop 0
    v_mfma_f32_16x16x32_bf16 v[20:23], v[32:35], v[156:159], v[20:23]
    v_and_b32 v28, v64, v4
    v_and_b32 v29, v64, v5
    v_and_b32 v30, v64, v6
    v_and_b32 v31, v64, v7
    s_waitcnt vmcnt(23)
    s_nop 0
    v_mfma_f32_16x16x32_bf16 v[20:23], v[28:31], v[160:163], v[20:23]
    v_and_b32 v32, v65, v4
    v_and_b32 v33, v65, v5
    v_and_b32 v34, v65, v6
    v_and_b32 v35, v65, v7
    s_waitcnt vmcnt(22)
    s_nop 0
    v_mfma_f32_16x16x32_bf16 v[20:23], v[32:35], v[164:167], v[20:23]
    v_and_b32 v28, v66, v4
    v_and_b32 v29, v66, v5
    v_and_b32 v30, v66, v6
    v_and_b32 v31, v66, v7
    s_waitcnt vmcnt(21)
    s_nop 0
    v_mfma_f32_16x16x32_bf16 v[20:23], v[28:31], v[168:171], v[20:23]
    v_and_b32 v32, v67, v4
    v_and_b32 v33, v67, v5
    v_and_b32 v34, v67, v6
    v_and_b32 v35, v67, v7
    s_waitcnt vmcnt(20)
    s_nop 0
    v_mfma_f32_16x16x32_bf16 v[20:23], v[32:35], v[172:175], v[20:23]
    v_and_b32 v28, v68, v4
    v_and_b32 v29, v68, v5
    v_and_b32 v30, v68, v6
    v_and_b32 v31, v68, v7
    s_waitcnt vmcnt(19)
    s_nop 0
    v_mfma_f32_16x16x32_bf16 v[20:23], v[28:31], v[176:179], v[20:23]
    v_and_b32 v32, v69, v4
    v_and_b32 v33, v69, v5
    v_and_b32 v34, v69, v6
    v_and_b32 v35, v69, v7
    s_waitcnt vmcnt(18)
    s_nop 0
    v_mfma_f32_16x16x32_bf16 v[20:23], v[32:35], v[180:183], v[20:23]
    v_and_b32 v28, v70, v4
    v_and_b32 v29, v70, v5
    v_and_b32 v30, v70, v6
    v_and_b32 v31, v70, v7
    s_waitcnt vmcnt(17)
    s_nop 0
    v_mfma_f32_16x16x32_bf16 v[20:23], v[28:31], v[184:187], v[20:23]
    v_and_b32 v32, v71, v4
    v_and_b32 v33, v71, v5
    v_and_b32 v34, v71, v6
    v_and_b32 v35, v71, v7
    s_waitcnt vmcnt(16)
    s_nop 0
    v_mfma_f32_16x16x32_bf16 v[20:23], v[32:35], v[188:191], v[20:23]
    v_and_b32 v28, v72, v4
    v_and_b32 v29, v72, v5
    v_and_b32 v30, v72, v6
    v_and_b32 v31, v72, v7
    s_waitcnt vmcnt(15)
    s_nop 0
    v_mfma_f32_16x16x32_bf16 v[20:23], v[28:31], v[192:195], v[20:23]
    v_and_b32 v32, v73, v4
    v_and_b32 v33, v73, v5
    v_and_b32 v34, v73, v6
    v_and_b32 v35, v73, v7
    s_waitcnt vmcnt(14)
    s_nop 0
    v_mfma_f32_16x16x32_bf16 v[20:23], v[32:35], v[196:199], v[20:23]
    v_and_b32 v28, v74, v4
    v_and_b32 v29, v74, v5
    v_and_b32 v30, v74, v6
    v_and_b32 v31, v74, v7
    s_waitcnt vmcnt(13)
    s_nop 0
    v_mfma_f32_16x16x32_bf16 v[20:23], v[28:31], v[200:203], v[20:23]
    v_and_b32 v32, v75, v4
    v_and_b32 v33, v75, v5
    v_and_b32 v34, v75, v6
    v_and_b32 v35, v75, v7
    s_waitcnt vmcnt(12)
    s_nop 0
    v_mfma_f32_16x16x32_bf16 v[20:23], v[32:35], v[204:207], v[20:23]
    v_and_b32 v28, v76, v4
    v_and_b32 v29, v76, v5
    v_and_b32 v30, v76, v6
    v_and_b32 v31, v76, v7
    s_waitcnt vmcnt(11)
    s_nop 0
    v_mfma_f32_16x16x32_bf16 v[20:23], v[28:31], v[208:211], v[20:23]
    v_and_b32 v32, v77, v4
    v_and_b32 v33, v77, v5
    v_and_b32 v34, v77, v6
    v_and_b32 v35, v77, v7
    s_waitcnt vmcnt(10)
    s_nop 0
    v_mfma_f32_16x16x32_bf16 v[20:23], v[32:35], v[212:215], v[20:23]
    v_and_b32 v28, v78, v4
    v_and_b32 v29, v78, v5
    v_and_b32 v30, v78, v6
    v_and_b32 v31, v78, v7
    s_waitcnt vmcnt(9)
    s_nop 0
    v_mfma_f32_16x16x32_bf16 v[20:23], v[28:31], v[216:219], v[20:23]
    v_and_b32 v32, v79, v4
    v_and_b32 v33, v79, v5
    v_and_b32 v34, v79, v6
    v_and_b32 v35, v79, v7
    s_waitcnt vmcnt(8)
    s_nop 0
    v_mfma_f32_16x16x32_bf16 v[20:23], v[32:35], v[220:223], v[20:23]
    v_and_b32 v28, v80, v4
    v_and_b32 v29, v80, v5
    v_and_b32 v30, v80, v6
    v_and_b32 v31, v80, v7
    s_waitcnt vmcnt(7)
    s_nop 0
    v_mfma_f32_16x16x32_bf16 v[20:23], v[28:31], v[224:227], v[20:23]
    v_and_b32 v32, v81, v4
    v_and_b32 v33, v81, v5
    v_and_b32 v34, v81, v6
    v_and_b32 v35, v81, v7
    s_waitcnt vmcnt(6)
    s_nop 0
    v_mfma_f32_16x16x32_bf16 v[20:23], v[32:35], v[228:231], v[20:23]
    v_and_b32 v28, v82, v4
    v_and_b32 v29, v82, v5
    v_and_b32 v30, v82, v6
    v_and_b32 v31, v82, v7
    s_waitcnt vmcnt(5)
    s_nop 0
    v_mfma_f32_16x16x32_bf16 v[20:23], v[28:31], v[232:235], v[20:23]
    v_and_b32 v32, v83, v4
    v_and_b32 v33, v83, v5
    v_and_b32 v34, v83, v6
    v_and_b32 v35, v83, v7
    s_waitcnt vmcnt(4)
    s_nop 0
    v_mfma_f32_16x16x32_bf16 v[20:23], v[32:35], v[236:239], v[20:23]
    v_and_b32 v28, v84, v4
    v_and_b32 v29, v84, v5
    v_and_b32 v30, v84, v6
    v_and_b32 v31, v84, v7
    s_waitcnt vmcnt(3)
    s_nop 0
    v_mfma_f32_16x16x32_bf16 v[20:23], v[28:31], v[240:243], v[20:23]
    v_and_b32 v32, v85, v4
    v_and_b32 v33, v85, v5
    v_and_b32 v34, v85, v6
    v_and_b32 v35, v85, v7
    s_waitcnt vmcnt(2)
    s_nop 0
    v_mfma_f32_16x16x32_bf16 v[20:23], v[32:35], v[244:247], v[20:23]
    v_and_b32 v28, v86, v4
    v_and_b32 v29, v86, v5
    v_and_b32 v30, v86, v6
    v_and_b32 v31, v86, v7
    s_waitcnt vmcnt(1)
    s_nop 0
    v_mfma_f32_16x16x32_bf16 v[20:23], v[28:31], v[248:251], v[20:23]
    v_and_b32 v32, v87, v4
    v_and_b32 v33, v87, v5
    v_and_b32 v34, v87, v6
    v_and_b32 v35, v87, v7
    s_waitcnt vmcnt(0)
    s_nop 0
    v_mfma_f32_16x16x32_bf16 v[20:23], v[32:35], v[252:255], v[20:23]
    v_and_b32 v8, 15, v1
    v_lshlrev_b32 v8, 5, v8
    v_lshrrev_b32 v9, 4, v1
    v_lshl_add_u32 v17, v9, 4, v8
    s_lshl_b32 s7, s9, 9
    v_add_u32 v8, s7, v17
    s_nop 3
    s_mov_b32 exec_hi, 0
    ds_write_b128 v8, v[20:23] offset:5120
    s_mov_b64 exec, -1
    s_waitcnt lgkmcnt(0)
    s_add_u32 s77, s77, 0x9e3779b9
    s_barrier
    s_lshl_b32 s7, s9, 6
    v_add_u32 v18, s7, v1
    v_lshrrev_b32 v8, 4, v1
    v_lshlrev_b32 v8, 3, v8
    s_lshl_b32 s7, s9, 5
    v_add_u32 v19, s7, v8
    v_mul_u32_u24 v8, 1280, v19
    v_and_b32 v9, 15, v1
    v_lshl_add_u32 v8, v9, 4, v8
    s_mul_i32 s8, s5, 163840
    s_add_u32 s44, s24, s8
    s_addc_u32 s45, s25, 0
    s_mov_b32 s46, 163840
    s_mov_b32 s48, 3840
    s_mov_b32 s49, 7680
    s_waitcnt vmcnt(0)
    buffer_load_dwordx4 v[96:99], v8, s[44:47], 0 offen offset:0
    s_waitcnt vmcnt(0)
    buffer_load_dwordx4 v[100:103], v8, s[44:47], 0 offen offset:256
    s_waitcnt vmcnt(0)
    buffer_load_dwordx4 v[104:107], v8, s[44:47], 0 offen offset:512
    s_waitcnt vmcnt(0)
    buffer_load_dwordx4 v[108:111], v8, s[44:47], 0 offen offset:768
    s_waitcnt vmcnt(0)
    buffer_load_dwordx4 v[112:115], v8, s[44:47], 0 offen offset:1024
    s_waitcnt vmcnt(0)
    buffer_load_dwordx4 v[116:119], v8, s[44:47], 0 offen offset:1280
    s_waitcnt vmcnt(0)
    buffer_load_dwordx4 v[120:123], v8, s[44:47], 0 offen offset:1536
    s_waitcnt vmcnt(0)
    buffer_load_dwordx4 v[124:127], v8, s[44:47], 0 offen offset:1792
    s_waitcnt vmcnt(0)
    buffer_load_dwordx4 v[128:131], v8, s[44:47], 0 offen offset:2048
    s_waitcnt vmcnt(0)
    buffer_load_dwordx4 v[132:135], v8, s[44:47], 0 offen offset:2304
    s_waitcnt vmcnt(0)
    buffer_load_dwordx4 v[136:139], v8, s[44:47], 0 offen offset:2560
    s_waitcnt vmcnt(0)
    buffer_load_dwordx4 v[140:143], v8, s[44:47], 0 offen offset:2816
    s_waitcnt vmcnt(0)
    buffer_load_dwordx4 v[144:147], v8, s[44:47], 0 offen offset:3072
    s_waitcnt vmcnt(0)
    buffer_load_dwordx4 v[148:151], v8, s[44:47], 0 offen offset:3328
    s_waitcnt vmcnt(0)
    buffer_load_dwordx4 v[152:155], v8, s[44:47], 0 offen offset:3584
    s_waitcnt vmcnt(0)
    buffer_load_dwordx4 v[156:159], v8, s[44:47], s48 offen offset:0
    s_waitcnt vmcnt(0)
    buffer_load_dwordx4 v[160:163], v8, s[44:47], s48 offen offset:256
    s_waitcnt vmcnt(0)
    buffer_load_dwordx4 v[164:167], v8, s[44:47], s48 offen offset:512
    s_waitcnt vmcnt(0)
    buffer_load_dwordx4 v[168:171], v8, s[44:47], s48 offen offset:768
    s_waitcnt vmcnt(0)
    buffer_load_dwordx4 v[172:175], v8, s[44:47], s48 offen offset:1024
    s_waitcnt vmcnt(0)
    buffer_load_dwordx4 v[176:179], v8, s[44:47], s48 offen offset:1280
    s_waitcnt vmcnt(0)
    buffer_load_dwordx4 v[180:183], v8, s[44:47], s48 offen offset:1536
    s_waitcnt vmcnt(0)
    buffer_load_dwordx4 v[184:187], v8, s[44:47], s48 offen offset:1792
    s_waitcnt vmcnt(0)
    buffer_load_dwordx4 v[188:191], v8, s[44:47], s48 offen offset:2048
    s_waitcnt vmcnt(0)
    buffer_load_dwordx4 v[192:195], v8, s[44:47], s48 offen offset:2304
    s_waitcnt vmcnt(0)
    buffer_load_dwordx4 v[196:199], v8, s[44:47], s48 offen offset:2560
    s_waitcnt vmcnt(0)
    buffer_load_dwordx4 v[200:203], v8, s[44:47], s48 offen offset:2816
    s_waitcnt vmcnt(0)
    buffer_load_dwordx4 v[204:207], v8, s[44:47], s48 offen offset:3072
    s_waitcnt vmcnt(0)
    buffer_load_dwordx4 v[208:211], v8, s[44:47], s48 offen offset:3328
    s_waitcnt vmcnt(0)
    buffer_load_dwordx4 v[212:215], v8, s[44:47], s48 offen offset:3584
    s_waitcnt vmcnt(0)
    buffer_load_dwordx4 v[216:219], v8, s[44:47], s49 offen offset:0
    s_waitcnt vmcnt(0)
    buffer_load_dwordx4 v[220:223], v8, s[44:47], s49 offen offset:256
    s_waitcnt vmcnt(0)
    buffer_load_dwordx4 v[224:227], v8, s[44:47], s49 offen offset:512
    s_waitcnt vmcnt(0)
    buffer_load_dwordx4 v[228:231], v8, s[44:47], s49 offen offset:768
    s_waitcnt vmcnt(0)
    buffer_load_dwordx4 v[232:235], v8, s[44:47], s49 offen offset:1024
    s_waitcnt vmcnt(0)
    buffer_load_dwordx4 v[236:239], v8, s[44:47], s49 offen offset:1280
    s_waitcnt vmcnt(0)
    buffer_load_dwordx4 v[240:243], v8, s[44:47], s49 offen offset:1536
    s_waitcnt vmcnt(0)
    buffer_load_dwordx4 v[244:247], v8, s[44:47], s49 offen offset:1792
    s_waitcnt vmcnt(0)
    buffer_load_dwordx4 v[248:251], v8, s[44:47], s49 offen offset:2048
    s_waitcnt vmcnt(0)
    buffer_load_dwordx4 v[252:255], v8, s[44:47], s49 offen offset:2304
    s_cmp_lg_u32 s9, 3
    s_cbranch_scc1 L_cnta
    s_waitcnt vmcnt(0)
    s_lshl_b32 s7, s2, 7
    s_add_u32 s7, s7, 693248
    v_add_u32 v10, s7, v26
    v_mov_b32 v12, s77
    v_mov_b32 v13, s77
    v_mov_b32 v14, s77
    v_mov_b32 v15, s77
    s_mov_b64 exec, 0xff
    global_store_dwordx4 v10, v[12:15], s[38:39] sc1
    s_mov_b64 exec, -1
L_cnta:
    v_lshlrev_b32 v44, 4, v18
    v_lshlrev_b32 v19, 2, v19
    s_mul_i32 s7, s9, 2560
    v_add_u32 v17, s7, v17
    v_mov_b32 v16, 0
    s_waitcnt vmcnt(0)
L_wet:
    s_cmp_lg_u32 s9, 3
    s_cbranch_scc1 L_cntd
    s_cmp_eq_u32 s66, 3
    s_cbranch_scc1 L_cntd
    s_mov_b32 s64, 524288
L_flg:
    s_sleep 32
    ds_read_b32 v8, v16 offset:9280
    s_waitcnt lgkmcnt(0)
    v_readfirstlane_b32 s7, v8
    s_cmp_lg_u32 s7, 0
    s_cbranch_scc1 L_flgd
    s_sub_u32 s64, s64, 1
    s_cbranch_scc0 L_flg
L_flgd:
    s_mov_b32 s64, 524288
    v_lshlrev_b32 v9, 7, v1
    v_add_u32 v9, 693248, v9
    v_add_u32 v10, 8192, v9
    v_add_u32 v14, 8192, v10
    v_add_u32 v15, 8192, v14
L_cnt:
    global_load_dword v8, v9, s[38:39] sc1
    global_load_dword v11, v10, s[38:39] sc1
    global_load_dword v12, v14, s[38:39] sc1
    global_load_dword v13, v15, s[38:39] sc1
    s_waitcnt vmcnt(0)
    v_xor_b32 v8, s77, v8
    v_xor_b32 v11, s77, v11
    v_xor_b32 v12, s77, v12
    v_xor_b32 v13, s77, v13
    v_or3_b32 v8, v8, v11, v12
    v_or_b32 v8, v8, v13
    v_cmp_ne_u32 vcc, 0, v8
    s_cbranch_vccz L_cntd
    s_sleep 127
    s_sub_u32 s64, s64, 1
    s_cbranch_scc0 L_cnt
L_cntd:
    s_setprio 2
    s_waitcnt lgkmcnt(0)
    s_barrier
L_mrg:
    ds_read_b128 v[48:51], v19 offset:7168
    ds_read_b128 v[56:59], v19 offset:7680
    ds_read_b128 v[64:67], v19 offset:8192
    ds_read_b128 v[72:75], v19 offset:8704
    ds_read_b128 v[52:55], v19 offset:7184
    ds_read_b128 v[60:63], v19 offset:7696
    ds_read_b128 v[68:71], v19 offset:8208
    ds_read_b128 v[76:79], v19 offset:8720
    s_waitcnt lgkmcnt(4)
    v_pk_add_f32 v[48:49], v[48:49], v[56:57]
    v_pk_add_f32 v[64:65], v[64:65], v[72:73]
    v_pk_add_f32 v[50:51], v[50:51], v[58:59]
    v_pk_add_f32 v[66:67], v[66:67], v[74:75]
    v_pk_add_f32 v[48:49], v[48:49], v[64:65]
    v_pk_add_f32 v[50:51], v[50:51], v[66:67]
    v_cvt_pk_bf16_f32 v48, v48, v48
    v_cvt_pk_bf16_f32 v49, v49, v49
    v_cvt_pk_bf16_f32 v50, v50, v50
    v_cvt_pk_bf16_f32 v51, v51, v51
    v_and_b32 v28, v48, v4
    v_and_b32 v29, v48, v5
    v_and_b32 v30, v48, v6
    v_and_b32 v31, v48, v7
    s_waitcnt lgkmcnt(0)
    s_nop 0
    v_mfma_f32_16x16x32_bf16 v[8:11], v[28:31], v[96:99], 0
    v_and_b32 v32, v49, v4
    v_and_b32 v33, v49, v5
    v_and_b32 v34, v49, v6
    v_mfma_f32_16x16x32_bf16 v[12:15], v[28:31], v[100:103], 0
    v_and_b32 v35, v49, v7
    v_pk_add_f32 v[52:53], v[52:53], v[60:61]
    v_pk_add_f32 v[68:69], v[68:69], v[76:77]
    v_mfma_f32_16x16x32_bf16 v[20:23], v[28:31], v[104:107], 0
    v_pk_add_f32 v[54:55], v[54:55], v[62:63]
    v_pk_add_f32 v[70:71], v[70:71], v[78:79]
    v_pk_add_f32 v[52:53], v[52:53], v[68:69]
    v_mfma_f32_16x16x32_bf16 v[36:39], v[28:31], v[108:111], 0
    v_mfma_f32_16x16x32_bf16 v[40:43], v[28:31], v[112:115], 0
    s_nop 0
    v_mfma_f32_16x16x32_bf16 v[8:11], v[32:35], v[116:119], v[8:11]
    v_and_b32 v28, v50, v4
    v_and_b32 v29, v50, v5
    v_and_b32 v30, v50, v6
    v_mfma_f32_16x16x32_bf16 v[12:15], v[32:35], v[120:123], v[12:15]
    v_and_b32 v31, v50, v7
    v_pk_add_f32 v[54:55], v[54:55], v[70:71]
    v_cvt_pk_bf16_f32 v52, v52, v52
    v_mfma_f32_16x16x32_bf16 v[20:23], v[32:35], v[124:127], v[20:23]
    v_cvt_pk_bf16_f32 v53, v53, v53
    v_cvt_pk_bf16_f32 v54, v54, v54
    v_cvt_pk_bf16_f32 v55, v55, v55
    v_mfma_f32_16x16x32_bf16 v[36:39], v[32:35], v[128:131], v[36:39]
    v_mfma_f32_16x16x32_bf16 v[40:43], v[32:35], v[132:135], v[40:43]
    s_nop 0
    v_mfma_f32_16x16x32_bf16 v[8:11], v[28:31], v[136:139], v[8:11]
    v_and_b32 v32, v51, v4
    v_mfma_f32_16x16x32_bf16 v[12:15], v[28:31], v[140:143], v[12:15]
    v_and_b32 v33, v51, v5
    v_mfma_f32_16x16x32_bf16 v[20:23], v[28:31], v[144:147], v[20:23]
    v_and_b32 v34, v51, v6
    v_mfma_f32_16x16x32_bf16 v[36:39], v[28:31], v[148:151], v[36:39]
    v_and_b32 v35, v51, v7
    v_mfma_f32_16x16x32_bf16 v[40:43], v[28:31], v[152:155], v[40:43]
    s_nop 0
    v_mfma_f32_16x16x32_bf16 v[8:11], v[32:35], v[156:159], v[8:11]
    v_and_b32 v28, v52, v4
    v_mfma_f32_16x16x32_bf16 v[12:15], v[32:35], v[160:163], v[12:15]
    v_and_b32 v29, v52, v5
    v_mfma_f32_16x16x32_bf16 v[20:23], v[32:35], v[164:167], v[20:23]
    v_and_b32 v30, v52, v6
    v_mfma_f32_16x16x32_bf16 v[36:39], v[32:35], v[168:171], v[36:39]
    v_and_b32 v31, v52, v7
    v_mfma_f32_16x16x32_bf16 v[40:43], v[32:35], v[172:175], v[40:43]
    s_nop 0
    v_mfma_f32_16x16x32_bf16 v[8:11], v[28:31], v[176:179], v[8:11]
    v_and_b32 v32, v53, v4
    v_mfma_f32_16x16x32_bf16 v[12:15], v[28:31], v[180:183], v[12:15]
    v_and_b32 v33, v53, v5
    v_mfma_f32_16x16x32_bf16 v[20:23], v[28:31], v[184:187], v[20:23]
    v_and_b32 v34, v53, v6
    v_mfma_f32_16x16x32_bf16 v[36:39], v[28:31], v[188:191], v[36:39]
    v_and_b32 v35, v53, v7
    v_mfma_f32_16x16x32_bf16 v[40:43], v[28:31], v[192:195], v[40:43]
    s_nop 0
    v_mfma_f32_16x16x32_bf16 v[8:11], v[32:35], v[196:199], v[8:11]
    v_and_b32 v28, v54, v4
    v_mfma_f32_16x16x32_bf16 v[12:15], v[32:35], v[200:203], v[12:15]
    v_and_b32 v29, v54, v5
    v_mfma_f32_16x16x32_bf16 v[20:23], v[32:35], v[204:207], v[20:23]
    v_and_b32 v30, v54, v6
    v_mfma_f32_16x16x32_bf16 v[36:39], v[32:35], v[208:211], v[36:39]
    v_and_b32 v31, v54, v7
    v_mfma_f32_16x16x32_bf16 v[40:43], v[32:35], v[212:215], v[40:43]
    s_nop 0
    v_mfma_f32_16x16x32_bf16 v[8:11], v[28:31], v[216:219], v[8:11]
    v_and_b32 v32, v55, v4
    v_mfma_f32_16x16x32_bf16 v[12:15], v[28:31], v[220:223], v[12:15]
    v_and_b32 v33, v55, v5
    v_mfma_f32_16x16x32_bf16 v[20:23], v[28:31], v[224:227], v[20:23]
    v_and_b32 v34, v55, v6
    v_mfma_f32_16x16x32_bf16 v[36:39], v[28:31], v[228:231], v[36:39]
    v_and_b32 v35, v55, v7
    v_mfma_f32_16x16x32_bf16 v[40:43], v[28:31], v[232:235], v[40:43]
    s_nop 0
    v_mfma_f32_16x16x32_bf16 v[8:11], v[32:35], v[236:239], v[8:11]
    v_mfma_f32_16x16x32_bf16 v[12:15], v[32:35], v[240:243], v[12:15]
    v_mfma_f32_16x16x32_bf16 v[20:23], v[32:35], v[244:247], v[20:23]
    v_mfma_f32_16x16x32_bf16 v[36:39], v[32:35], v[248:251], v[36:39]
    v_mfma_f32_16x16x32_bf16 v[40:43], v[32:35], v[252:255], v[40:43]
    s_nop 0
    s_mov_b32 exec_hi, 0
    s_nop 3
    ds_write_b128 v17, v[8:11] offset:25728
    ds_write_b128 v17, v[12:15] offset:26240
    ds_write_b128 v17, v[20:23] offset:26752
    ds_write_b128 v17, v[36:39] offset:27264
    ds_write_b128 v17, v[40:43] offset:27776
    s_mov_b64 exec, -1
    s_waitcnt lgkmcnt(0)
    s_barrier
    s_cmp_eq_u32 s9, 3
    s_cbranch_scc1 L_pubd
L_nob3:
    ds_read_b128 v[48:51], v44 offset:25728
    ds_read_b128 v[52:55], v44 offset:28288
    ds_read_b128 v[56:59], v44 offset:30848
    ds_read_b128 v[60:63], v44 offset:33408
    s_cmp_eq_u32 s9, 2
    s_cselect_b32 exec_hi, 0, -1
    s_waitcnt lgkmcnt(0)
    v_pk_add_f32 v[48:49], v[48:49], v[52:53]
    v_pk_add_f32 v[56:57], v[56:57], v[60:61]
    v_pk_add_f32 v[50:51], v[50:51], v[54:55]
    v_pk_add_f32 v[58:59], v[58:59], v[62:63]
    v_pk_add_f32 v[48:49], v[48:49], v[56:57]
    v_pk_add_f32 v[50:51], v[50:51], v[58:59]
    v_min_u32 v48, -2, v48
    v_min_u32 v49, -2, v49
    v_min_u32 v50, -2, v50
    v_min_u32 v51, -2, v51
    global_store_dwordx4 v45, v[48:51], s[38:39] sc1
    s_mov_b64 exec, -1
L_pubd:
    s_cmp_ge_u32 s66, 2
    s_cbranch_scc1 L_end
    s_barrier
    s_barrier
    v_lshrrev_b32 v46, 4, v1
    v_lshlrev_b32 v46, 3, v46
    v_bfe_u32 v47, v1, 2, 2
    v_add_u32 v46, v46, v47
    v_and_b32 v47, 3, v1
    v_lshlrev_b32 v47, 3, v47
    v_add_u32 v47, 46336, v47
    s_cmp_eq_u32 s66, 0
    s_cbranch_scc1 L_wa_9
    v_lshl_add_u32 v46, v46, 5, v47
    s_lshl_b32 s7, s3, 10
    v_add_u32 v46, s7, v46
    ds_read_b64_tr_b16 v[64:65], v46 offset:0
    ds_read_b64_tr_b16 v[66:67], v46 offset:128
    ds_read_b64_tr_b16 v[68:69], v46 offset:8192
    ds_read_b64_tr_b16 v[70:71], v46 offset:8320
    ds_read_b64_tr_b16 v[72:73], v46 offset:16384
    ds_read_b64_tr_b16 v[74:75], v46 offset:16512
    ds_read_b64_tr_b16 v[76:77], v46 offset:24576
    ds_read_b64_tr_b16 v[78:79], v46 offset:24704
    ds_read_b64_tr_b16 v[80:81], v46 offset:32768
    ds_read_b64_tr_b16 v[82:83], v46 offset:32896
    ds_read_b64_tr_b16 v[84:85], v46 offset:40960
    ds_read_b64_tr_b16 v[86:87], v46 offset:41088
    ds_read_b64_tr_b16 v[88:89], v46 offset:49152
    ds_read_b64_tr_b16 v[90:91], v46 offset:49280
    s_branch L_wd_10
L_wa_9:
L_wd_10:
L_tail:
    s_cmp_eq_u32 s66, 0
    s_cbranch_scc0 L_tailB
    s_mul_i32 s7, s3, 1280
    s_add_u32 s7, s7, 655360
    v_lshl_add_u32 v8, v1, 4, s7
    v_lshl_add_u32 v9, v1, 2, s7
    s_mul_i32 s7, s3, 1296
    v_lshl_add_u32 v48, v1, 4, s7
    v_lshl_add_u32 v49, v1, 2, s7
    v_and_b32 v50, 7, v1
    v_mul_u32_u24 v51, 1296, v50
    v_lshrrev_b32 v17, 4, v1
    v_lshl_add_u32 v51, v17, 4, v51
    v_lshlrev_b32 v50, 4, v50
    s_lshl_b32 s7, s67, 1
    s_add_u32 s7, s7, s3
    s_lshl_b32 s7, s7, 7
    s_add_u32 s7, s7, 665344
    v_add_u32 v50, s7, v50
    v_lshlrev_b32 v46, 3, v17
    v_bfe_u32 v47, v1, 2, 2
    v_add_u32 v46, v46, v47
    v_and_b32 v47, 3, v1
    v_lshlrev_b32 v47, 3, v47
    v_lshl_add_u32 v46, v46, 6, v47
    s_lshl_b32 s7, s3, 5
    s_add_u32 s7, s7, 46272
    v_add_u32 v46, s7, v46
    s_mov_b32 s55, 0xbfb8aa3b
    s_mov_b64 s[62:63], exec
    s_mov_b32 s64, 524288
L_poll_11:
    global_load_dwordx4 v[12:15], v8, s[38:39] sc1
    global_load_dword v16, v9, s[38:39] offset:1024 sc1
L_hchk:
    s_waitcnt vmcnt(0)
    v_max3_u32 v18, v12, v13, v14
    v_max3_u32 v18, v18, v15, v16
    v_cmpx_eq_u32 vcc, -1, v18
    s_cbranch_execz L_polld_12
    s_sub_u32 s64, s64, 1
    s_cbranch_scc0 L_poll_11
L_polld_12:
    s_mov_b64 exec, s[62:63]
    s_nop 2
    v_lshlrev_b32 v28, 16, v12
    v_and_b32 v29, 0xffff0000, v12
    v_lshlrev_b32 v30, 16, v13
    v_and_b32 v31, 0xffff0000, v13
    v_lshlrev_b32 v32, 16, v14
    v_and_b32 v33, 0xffff0000, v14
    v_lshlrev_b32 v34, 16, v15
    v_and_b32 v35, 0xffff0000, v15
    v_lshlrev_b32 v36, 16, v16
    v_and_b32 v37, 0xffff0000, v16
    s_mov_b32 s61, 0x3acccccd
    v_readfirstlane_b32 s58, v28
    v_readfirstlane_b32 s59, v28
    s_nop 1
    v_pk_add_f32 v[40:41], v[28:29], s[58:59] neg_lo:[0,1] neg_hi:[0,1]
    v_pk_mul_f32 v[42:43], v[40:41], v[40:41]
    v_pk_add_f32 v[20:21], v[30:31], s[58:59] neg_lo:[0,1] neg_hi:[0,1]
    v_pk_add_f32 v[40:41], v[40:41], v[20:21]
    v_pk_fma_f32 v[42:43], v[20:21], v[20:21], v[42:43]
    v_pk_add_f32 v[20:21], v[32:33], s[58:59] neg_lo:[0,1] neg_hi:[0,1]
    v_pk_add_f32 v[40:41], v[40:41], v[20:21]
    v_pk_fma_f32 v[42:43], v[20:21], v[20:21], v[42:43]
    v_pk_add_f32 v[20:21], v[34:35], s[58:59] neg_lo:[0,1] neg_hi:[0,1]
    v_pk_add_f32 v[40:41], v[40:41], v[20:21]
    v_pk_fma_f32 v[42:43], v[20:21], v[20:21], v[42:43]
    v_pk_add_f32 v[20:21], v[36:37], s[58:59] neg_lo:[0,1] neg_hi:[0,1]
    v_pk_add_f32 v[40:41], v[40:41], v[20:21]
    v_pk_fma_f32 v[42:43], v[20:21], v[20:21], v[42:43]
    v_add_f32 v40, v40, v41
    v_add_f32 v42, v42, v43
    s_nop 0
    v_add_f32_dpp v40, v40, v40 row_ror:8 row_mask:0xf bank_mask:0xf
    v_add_f32_dpp v42, v42, v42 row_ror:8 row_mask:0xf bank_mask:0xf
    s_nop 0
    v_add_f32_dpp v40, v40, v40 row_ror:4 row_mask:0xf bank_mask:0xf
    v_add_f32_dpp v42, v42, v42 row_ror:4 row_mask:0xf bank_mask:0xf
    s_nop 0
    v_add_f32_dpp v40, v40, v40 row_ror:2 row_mask:0xf bank_mask:0xf
    v_add_f32_dpp v42, v42, v42 row_ror:2 row_mask:0xf bank_mask:0xf
    s_nop 0
    v_add_f32_dpp v40, v40, v40 row_ror:1 row_mask:0xf bank_mask:0xf
    v_add_f32_dpp v42, v42, v42 row_ror:1 row_mask:0xf bank_mask:0xf
    s_nop 0
    v_add_f32_dpp v40, v40, v40 row_bcast:15 row_mask:0xa bank_mask:0xf
    v_add_f32_dpp v42, v42, v42 row_bcast:15 row_mask:0xa bank_mask:0xf
    s_nop 0
    v_add_f32_dpp v40, v40, v40 row_bcast:31 row_mask:0xc bank_mask:0xf
    v_add_f32_dpp v42, v42, v42 row_bcast:31 row_mask:0xc bank_mask:0xf
    v_readlane_b32 s60, v40, 63
    v_readlane_b32 s58, v42, 63
    s_nop 0
    v_mov_b32 v40, s60
    v_mov_b32 v42, s58
    v_mul_f32 v40, s61, v40
    v_mul_f32 v42, s61, v42
    v_fma_f32 v42, -v40, v40, v42
    v_add_f32 v40, s59, v40
    v_max_f32 v42, 0, v42
    v_cvt_pk_bf16_f32 v40, v40, v42
    v_and_b32 v42, 0xffff0000, v40
    v_lshlrev_b32 v40, 16, v40
    v_add_f32 v42, 0x3727c5ac, v42
    v_cvt_pk_bf16_f32 v42, v42, v42
    v_lshlrev_b32 v42, 16, v42
    v_sqrt_f32 v42, v42
    v_pk_add_f32 v[28:29], v[28:29], v[40:41] op_sel_hi:[1,0] neg_lo:[0,1] neg_hi:[0,1]
    v_pk_add_f32 v[30:31], v[30:31], v[40:41] op_sel_hi:[1,0] neg_lo:[0,1] neg_hi:[0,1]
    v_pk_add_f32 v[32:33], v[32:33], v[40:41] op_sel_hi:[1,0] neg_lo:[0,1] neg_hi:[0,1]
    v_pk_add_f32 v[34:35], v[34:35], v[40:41] op_sel_hi:[1,0] neg_lo:[0,1] neg_hi:[0,1]
    v_pk_add_f32 v[36:37], v[36:37], v[40:41] op_sel_hi:[1,0] neg_lo:[0,1] neg_hi:[0,1]
    v_cvt_pk_bf16_f32 v42, v42, v42
    v_lshlrev_b32 v42, 16, v42
    v_rcp_f32 v43, v42
    v_cvt_pk_bf16_f32 v20, v28, v29
    v_cvt_pk_bf16_f32 v21, v30, v31
    v_cvt_pk_bf16_f32 v22, v32, v33
    v_cvt_pk_bf16_f32 v23, v34, v35
    v_cvt_pk_bf16_f32 v24, v36, v37
    v_lshlrev_b32 v28, 16, v20
    v_and_b32 v29, 0xffff0000, v20
    v_lshlrev_b32 v30, 16, v21
    v_and_b32 v31, 0xffff0000, v21
    v_lshlrev_b32 v32, 16, v22
    v_and_b32 v33, 0xffff0000, v22
    v_lshlrev_b32 v34, 16, v23
    v_and_b32 v35, 0xffff0000, v23
    v_lshlrev_b32 v36, 16, v24
    v_and_b32 v37, 0xffff0000, v24
    v_pk_mul_f32 v[28:29], v[28:29], v[42:43] op_sel:[0,1] op_sel_hi:[1,1]
    v_pk_mul_f32 v[30:31], v[30:31], v[42:43] op_sel:[0,1] op_sel_hi:[1,1]
    v_pk_mul_f32 v[32:33], v[32:33], v[42:43] op_sel:[0,1] op_sel_hi:[1,1]
    v_pk_mul_f32 v[34:35], v[34:35], v[42:43] op_sel:[0,1] op_sel_hi:[1,1]
    v_pk_mul_f32 v[36:37], v[36:37], v[42:43] op_sel:[0,1] op_sel_hi:[1,1]
    v_cvt_pk_bf16_f32 v20, v28, v29
    v_cvt_pk_bf16_f32 v21, v30, v31
    v_cvt_pk_bf16_f32 v22, v32, v33
    v_cvt_pk_bf16_f32 v23, v34, v35
    v_cvt_pk_bf16_f32 v24, v36, v37
    ds_write_b128 v48, v[20:23] offset:35968
    ds_write_b32 v49, v24 offset:36992
    s_waitcnt lgkmcnt(0)
    s_barrier
    s_and_b32 s7, s3, 6
    s_cmp_lg_u32 s7, 2
    s_cbranch_scc1 L_end
    ds_read_b128 v[144:147], v51 offset:35968
    ds_read_b128 v[148:151], v51 offset:36032
    ds_read_b128 v[152:155], v51 offset:36096
    ds_read_b128 v[156:159], v51 offset:36160
    ds_read_b128 v[160:163], v51 offset:36224
    ds_read_b128 v[164:167], v51 offset:36288
    ds_read_b128 v[168:171], v51 offset:36352
    ds_read_b128 v[172:175], v51 offset:36416
    ds_read_b128 v[176:179], v51 offset:36480
    ds_read_b128 v[180:183], v51 offset:36544
    ds_read_b128 v[184:187], v51 offset:36608
    ds_read_b128 v[188:191], v51 offset:36672
    ds_read_b128 v[192:195], v51 offset:36736
    ds_read_b128 v[196:199], v51 offset:36800
    ds_read_b128 v[200:203], v51 offset:36864
    ds_read_b128 v[204:207], v51 offset:36928
    ds_read_b128 v[208:211], v51 offset:36992
    ds_read_b128 v[212:215], v51 offset:37056
    ds_read_b128 v[216:219], v51 offset:37120
    ds_read_b128 v[220:223], v51 offset:37184
    s_waitcnt lgkmcnt(15)
    v_mfma_f32_16x16x32_bf16 v[20:23], v[64:67], v[144:147], 0
    s_waitcnt lgkmcnt(15)
    v_mfma_f32_16x16x32_bf16 v[20:23], v[68:71], v[148:151], v[20:23]
    s_waitcnt lgkmcnt(15)
    v_mfma_f32_16x16x32_bf16 v[20:23], v[72:75], v[152:155], v[20:23]
    s_waitcnt lgkmcnt(15)
    v_mfma_f32_16x16x32_bf16 v[20:23], v[76:79], v[156:159], v[20:23]
    s_waitcnt lgkmcnt(15)
    v_mfma_f32_16x16x32_bf16 v[20:23], v[80:83], v[160:163], v[20:23]
    s_waitcnt lgkmcnt(14)
    v_mfma_f32_16x16x32_bf16 v[20:23], v[84:87], v[164:167], v[20:23]
    s_waitcnt lgkmcnt(13)
    v_mfma_f32_16x16x32_bf16 v[20:23], v[88:91], v[168:171], v[20:23]
    s_waitcnt lgkmcnt(12)
    v_mfma_f32_16x16x32_bf16 v[20:23], v[92:95], v[172:175], v[20:23]
    s_waitcnt lgkmcnt(11)
    v_mfma_f32_16x16x32_bf16 v[20:23], v[96:99], v[176:179], v[20:23]
    s_waitcnt lgkmcnt(10)
    v_mfma_f32_16x16x32_bf16 v[20:23], v[100:103], v[180:183], v[20:23]
    s_waitcnt lgkmcnt(9)
    v_mfma_f32_16x16x32_bf16 v[20:23], v[104:107], v[184:187], v[20:23]
    s_waitcnt lgkmcnt(8)
    v_mfma_f32_16x16x32_bf16 v[20:23], v[108:111], v[188:191], v[20:23]
    s_waitcnt lgkmcnt(7)
    v_mfma_f32_16x16x32_bf16 v[20:23], v[112:115], v[192:195], v[20:23]
    s_waitcnt lgkmcnt(6)
    v_mfma_f32_16x16x32_bf16 v[20:23], v[116:119], v[196:199], v[20:23]
    s_waitcnt lgkmcnt(5)
    v_mfma_f32_16x16x32_bf16 v[20:23], v[120:123], v[200:203], v[20:23]
    s_waitcnt lgkmcnt(4)
    v_mfma_f32_16x16x32_bf16 v[20:23], v[124:127], v[204:207], v[20:23]
    s_waitcnt lgkmcnt(3)
    v_mfma_f32_16x16x32_bf16 v[20:23], v[128:131], v[208:211], v[20:23]
    s_waitcnt lgkmcnt(2)
    v_mfma_f32_16x16x32_bf16 v[20:23], v[132:135], v[212:215], v[20:23]
    s_waitcnt lgkmcnt(1)
    v_mfma_f32_16x16x32_bf16 v[20:23], v[136:139], v[216:219], v[20:23]
    s_waitcnt lgkmcnt(0)
    v_mfma_f32_16x16x32_bf16 v[20:23], v[140:143], v[220:223], v[20:23]
    s_nop 7
    v_cvt_pk_bf16_f32 v20, v20, v21
    v_cvt_pk_bf16_f32 v22, v22, v23
    v_lshlrev_b32 v24, 16, v20
    v_and_b32 v25, 0xffff0000, v20
    v_mul_f32 v26, s55, v24
    v_mul_f32 v27, s55, v25
    v_exp_f32 v26, v26
    v_exp_f32 v27, v27
    v_lshlrev_b32 v28, 16, v22
    v_add_f32 v26, 1.0, v26
    v_add_f32 v27, 1.0, v27
    v_rcp_f32 v26, v26
    v_rcp_f32 v27, v27
    v_and_b32 v29, 0xffff0000, v22
    v_mul_f32 v24, v24, v26
    v_mul_f32 v25, v25, v27
    v_cvt_pk_bf16_f32 v24, v24, v25
    v_lshlrev_b32 v26, 16, v24
    v_and_b32 v27, 0xffff0000, v24
    v_mul_f32 v26, v26, v28
    v_mul_f32 v27, v27, v29
    v_cvt_pk_bf16_f32 v26, v26, v27
    v_min_u32 v24, -2, v26
    v_min_u32 v25, -2, v26
    s_nop 1
    v_permlane16_swap_b32 v24, v25
    v_mov_b32 v26, v24
    v_mov_b32 v27, v25
    s_nop 0
    v_permlane32_swap_b32 v24, v26
    v_permlane32_swap_b32 v25, v27
    s_mov_b64 exec, 0xff
    global_store_dwordx4 v50, v[24:27], s[38:39] sc1
    s_endpgm
L_tailB:
    s_load_dword s77, s[38:39], 726016
    v_and_b32 v10, 7, v1
    v_lshrrev_b32 v17, 4, v1
    v_lshlrev_b32 v8, 4, v10
    v_lshl_add_u32 v8, v17, 7, v8
    s_lshl_b32 s7, s3, 9
    s_add_u32 s7, s7, 665600
    v_add_u32 v8, s7, v8
    v_add_u32 v9, 0x2000, v8
    v_add_u32 v11, 0x4000, v8
    s_movk_i32 s8, 0x5000
    s_cmp_lt_u32 s3, 6
    s_cselect_b32 s8, 0x6000, s8
    v_add_u32 v12, s8, v8
    v_mul_u32_u24 v13, 1280, v10
    v_lshl_add_u32 v13, v17, 3, v13
    s_lshl_b32 s7, s67, 5
    v_add_u32 v13, s7, v13
    v_add_u32 v14, 655360, v13
    v_lshlrev_b32 v60, 6, v10
    v_lshl_add_u32 v60, v17, 4, v60
    s_lshl_b32 s7, s3, 9
    v_add_u32 v61, s7, v60
    s_add_u32 s68, s38, 4096
    s_addc_u32 s69, s39, 0
    s_cmp_lg_u32 s3, 3
    s_cbranch_scc1 L_noh
    s_mov_b64 s[62:63], exec
    s_mov_b32 s64, 524288
L_poll_13:
    global_load_dwordx2 v[18:19], v14, s[38:39] sc1
    s_waitcnt vmcnt(0)
    v_max_u32 v15, v18, v19
    v_cmpx_eq_u32 vcc, -1, v15
    s_cbranch_execz L_polld_14
    s_sub_u32 s64, s64, 1
    s_cbranch_scc0 L_poll_13
L_polld_14:
    s_mov_b64 exec, s[62:63]
    s_nop 2
L_noh:
    s_mov_b64 s[62:63], exec
    s_mov_b32 s64, 524288
L_poll_15:
    global_load_dwordx4 v[96:99], v8, s[38:39] sc1
    global_load_dwordx4 v[100:103], v8, s[68:69] sc1
    global_load_dwordx4 v[104:107], v9, s[38:39] sc1
    global_load_dwordx4 v[108:111], v9, s[68:69] sc1
    global_load_dwordx4 v[112:115], v11, s[38:39] sc1
    global_load_dwordx4 v[116:119], v11, s[68:69] sc1
    global_load_dwordx4 v[120:123], v12, s[38:39] sc1
    s_waitcnt vmcnt(0)
    v_max3_u32 v15, v96, v97, v98
    v_max3_u32 v15, v15, v99, v100
    v_max3_u32 v15, v15, v101, v102
    v_max3_u32 v15, v15, v103, v104
    v_max3_u32 v15, v15, v105, v106
    v_max3_u32 v15, v15, v107, v108
    v_max3_u32 v15, v15, v109, v110
    v_max3_u32 v15, v15, v111, v112
    v_max3_u32 v15, v15, v113, v114
    v_max3_u32 v15, v15, v115, v116
    v_max3_u32 v15, v15, v117, v118
    v_max3_u32 v15, v15, v119, v120
    v_max3_u32 v15, v15, v121, v122
    v_max_u32 v15, v15, v123
    v_cmpx_eq_u32 vcc, -1, v15
    s_cbranch_execz L_polld_16
    s_sub_u32 s64, s64, 1
    s_cbranch_scc0 L_poll_15
L_polld_16:
    s_mov_b64 exec, s[62:63]
    s_nop 2
    s_waitcnt lgkmcnt(0)
    v_mfma_f32_16x16x32_bf16 v[20:23], v[64:67], v[96:99], 0
    v_mfma_f32_16x16x32_bf16 v[20:23], v[68:71], v[100:103], v[20:23]
    v_mfma_f32_16x16x32_bf16 v[20:23], v[72:75], v[104:107], v[20:23]
    v_mfma_f32_16x16x32_bf16 v[20:23], v[76:79], v[108:111], v[20:23]
    v_mfma_f32_16x16x32_bf16 v[20:23], v[80:83], v[112:115], v[20:23]
    v_mfma_f32_16x16x32_bf16 v[20:23], v[84:87], v[116:119], v[20:23]
    v_mfma_f32_16x16x32_bf16 v[20:23], v[88:91], v[120:123], v[20:23]
    s_mov_b32 exec_lo, 0x00ff00ff
    s_mov_b32 exec_hi, 0x00ff00ff
    v_lshlrev_b32 v56, 16, v18
    v_and_b32 v57, 0xffff0000, v18
    v_lshlrev_b32 v58, 16, v19
    v_and_b32 v59, 0xffff0000, v19
    s_nop 1
    ds_write_b128 v61, v[20:23] offset:35968
    s_waitcnt lgkmcnt(0)
    s_barrier
    s_cmp_lg_u32 s3, 3
    s_cbranch_scc1 L_end
    ds_read_b128 v[24:27], v60 offset:35968
    ds_read_b128 v[28:31], v60 offset:36480
    ds_read_b128 v[32:35], v60 offset:36992
    ds_read_b128 v[36:39], v60 offset:37504
    ds_read_b128 v[40:43], v60 offset:38016
    ds_read_b128 v[44:47], v60 offset:38528
    ds_read_b128 v[48:51], v60 offset:39040
    ds_read_b128 v[52:55], v60 offset:39552
    s_waitcnt lgkmcnt(0)
    v_pk_add_f32 v[24:25], v[24:25], v[40:41]
    v_pk_add_f32 v[26:27], v[26:27], v[42:43]
    v_pk_add_f32 v[28:29], v[28:29], v[44:45]
    v_pk_add_f32 v[30:31], v[30:31], v[46:47]
    v_pk_add_f32 v[32:33], v[32:33], v[48:49]
    v_pk_add_f32 v[34:35], v[34:35], v[50:51]
    v_pk_add_f32 v[36:37], v[36:37], v[52:53]
    v_pk_add_f32 v[38:39], v[38:39], v[54:55]
    v_pk_add_f32 v[24:25], v[24:25], v[32:33]
    v_pk_add_f32 v[26:27], v[26:27], v[34:35]
    v_pk_add_f32 v[28:29], v[28:29], v[36:37]
    v_pk_add_f32 v[30:31], v[30:31], v[38:39]
    v_pk_add_f32 v[24:25], v[24:25], v[28:29]
    v_pk_add_f32 v[26:27], v[26:27], v[30:31]
    v_cvt_pk_bf16_f32 v24, v24, v25
    v_cvt_pk_bf16_f32 v26, v26, v27
    v_lshlrev_b32 v28, 16, v24
    v_and_b32 v29, 0xffff0000, v24
    v_lshlrev_b32 v30, 16, v26
    v_and_b32 v31, 0xffff0000, v26
    v_add_f32 v24, v56, v28
    v_add_f32 v25, v57, v29
    v_add_f32 v26, v58, v30
    v_add_f32 v27, v59, v31
    v_cvt_pk_bf16_f32 v24, v24, v25
    v_cvt_pk_bf16_f32 v25, v26, v27
    global_store_dwordx2 v13, v[24:25], s[34:35]
    s_cmp_lg_u32 s67, 0
    s_cbranch_scc1 L_noep
    s_add_u32 s77, s77, 0x9e3779b9
    s_mov_b64 exec, 1
    v_mov_b32 v28, 726016
    v_mov_b32 v29, s77
    global_store_dword v28, v29, s[38:39] sc1
L_noep:
L_end:
    s_endpgm
.section .rodata,"a"
.p2align 6
.amdhsa_kernel sequential_preLN__mha_block_cached__swiglu_ffn__decode_kernel
  .amdhsa_next_free_vgpr 256
  .amdhsa_next_free_sgpr 102
  .amdhsa_accum_offset 256
  .amdhsa_group_segment_fixed_size 0
  .amdhsa_kernarg_size 96
  .amdhsa_user_sgpr_count 2
  .amdhsa_user_sgpr_kernarg_segment_ptr 1
  .amdhsa_system_sgpr_workgroup_id_x 1
  .amdhsa_float_denorm_mode_32 3
.end_amdhsa_kernel
```
